```python
import torch

def _softmax(x, axis=-1):
    return torch.softmax(x, dim=axis)
def _gelu(x):
    return torch.nn.functional.gelu(x, approximate="tanh")
def _silu(x):
    return torch.nn.functional.silu(x)
def _sigmoid(x):
    return torch.sigmoid(x)
def _layernorm(x, axis=-1, eps=1e-5):
    m = x.mean(dim=axis, keepdim=True)
    v = x.var(dim=axis, keepdim=True, unbiased=False)
    return (x - m) / torch.sqrt(v + eps)
def _scatter_add(tgt, idx, src, axis=0):
    return tgt.clone().index_add_(axis, idx, src)
def _segment_sum(src, seg, n):
    out = torch.zeros((n,) + src.shape[1:], dtype=src.dtype)
    return out.index_add_(0, seg, src)
def _pad(x, pw):
    flat = tuple(v for pair in reversed(pw) for v in pair)
    return torch.nn.functional.pad(x, flat)

kernel_name = 'parallel_sum__grouped_kv_mqa__glu_gated_bilinear__prompt'

def setup_inputs():

    _w = (lambda a: (lambda t: t.to(torch.bfloat16) if t.is_floating_point() else t)(torch.as_tensor(a)))
    def _A_setup():
        B, S, D, H = 1, 2048, 448, 16
        Dh = D // H
        return {
            "x": _w((lambda *s: torch.randn(*s, dtype=torch.bfloat16) * 0.05)(B, S, D)),
            "wq": _w((lambda *s: torch.randn(*s, dtype=torch.bfloat16) * 0.05)(D, H * Dh)),
            "wk": _w((lambda *s: torch.randn(*s, dtype=torch.bfloat16) * 0.05)(D, Dh)),
            "wv": _w((lambda *s: torch.randn(*s, dtype=torch.bfloat16) * 0.05)(D, Dh)),
            "wo": _w((lambda *s: torch.randn(*s, dtype=torch.bfloat16) * 0.05)(H * Dh, D)),
        }
    _A_in = _A_setup()

    def _B_setup():
        B, S, D, F = 1, 2048, 448, 1792
        return {
            "x": _w((lambda *s: torch.randn(*s, dtype=torch.bfloat16) * 0.05)(B, S, D)),
            "w_gate": _w((lambda *s: torch.randn(*s, dtype=torch.bfloat16) * 0.4)(D, F) * (D ** -0.5)),
            "w_up": _w((lambda *s: torch.randn(*s, dtype=torch.bfloat16) * 0.4)(D, F) * (D ** -0.5)),
            "w_down": _w((lambda *s: torch.randn(*s, dtype=torch.bfloat16) * 0.4)(F, D) * (F ** -0.5)),
        }
    _B_in = _B_setup()

    return {
        "A_x": _A_in["x"],
        "A_wq": _A_in["wq"],
        "A_wk": _A_in["wk"],
        "A_wv": _A_in["wv"],
        "A_wo": _A_in["wo"],
        "B_x": _B_in["x"],
        "B_w_gate": _B_in["w_gate"],
        "B_w_up": _B_in["w_up"],
        "B_w_down": _B_in["w_down"],
    }

def reference(A_x, A_wq, A_wk, A_wv, A_wo, B_x, B_w_gate, B_w_up, B_w_down):
    def _A_ref(x, wq, wk, wv, wo):
        B, S, D = x.shape
        H = 16
        Dh = D // H
        q = (lambda x, *d: x.permute(*d))((x @ wq).reshape(B, S, H, Dh), 0, 2, 1, 3)
        k = x @ wk
        v = x @ wv
        scores = torch.einsum("bhqd,bkd->bhqk", q, k) * (Dh ** -0.5)
        p = _softmax(scores, axis=-1)
        o = torch.einsum("bhqk,bkd->bhqd", p, v)
        return (lambda x, *d: x.permute(*d))(o, 0, 2, 1, 3).reshape(B, S, H * Dh) @ wo

    def _B_ref(x, w_gate, w_up, w_down):
        g = torch.einsum("bsd,df->bsf", x, w_gate)
        u = torch.einsum("bsd,df->bsf", x, w_up)
        h = g * u
        return torch.einsum("bsf,fd->bsd", h, w_down)

    x = A_x
    xn = _layernorm(x, axis=-1)
    return x + _A_ref(xn, A_wq, A_wk, A_wv, A_wo) + _B_ref(xn, B_w_gate, B_w_up, B_w_down)
```

```asm
; @launch grid=(256,1,1) block=(512,1,1) lds=163840
.amdgcn_target "amdgcn-amd-amdhsa--gfx950"
.text
.globl parallel_sum__grouped_kv_mqa__glu_gated_bilinear__prompt_kernel
.p2align 8
.type parallel_sum__grouped_kv_mqa__glu_gated_bilinear__prompt_kernel,@function
parallel_sum__grouped_kv_mqa__glu_gated_bilinear__prompt_kernel:
    s_cmpk_ge_u32 s2, 256
    s_cbranch_scc1 L_end
    s_load_dwordx2 s[40:41], s[0:1], 0
    s_lshr_b32 s7, s2, 2
    s_and_b32 s7, s7, 8
    s_xor_b32 s8, s7, 56
    s_xor_b32 s7, s7, 48
    s_load_dwordx2 s[48:49], s[0:1], s7
    s_load_dwordx2 s[52:53], s[0:1], s8
    v_readfirstlane_b32 s3, v0
    s_getpc_b64 s[72:73]
L_pc:
    v_and_b32 v0, 63, v0
    s_lshr_b32 s8, s2, 5
    s_bfe_u32 s7, s2, 0x10001
    s_lshl1_add_u32 s4, s8, s7
    s_and_b32 s9, s2, 1
    s_bfe_u32 s11, s2, 0x20003
    s_lshl2_add_u32 s21, s9, s11
    s_mov_b32 s42, 1835008
    s_mov_b32 s43, 0x20000
    s_bfe_u32 s23, s3, 0x20006
    s_bitcmp1_b32 s2, 2
    s_cselect_b32 s5, 7, 0
    s_add_u32 s5, s5, s21
    s_cmp_eq_u32 s21, 7
    s_cbranch_scc1 L_spare
    s_cmpk_lt_u32 s3, 256
    s_cbranch_scc1 L_rest
    s_lshl2_add_u32 s7, s4, s23
    s_lshl_b32 s7, s7, 5
    s_and_b32 s9, s2, 8
    s_add_u32 s7, s7, s9
    s_lshr_b32 s9, s9, 1
    v_lshrrev_b32 v9, 3, v0
    v_add_u32 v9, s7, v9
    v_mul_u32_u24 v9, 896, v9
    v_lshrrev_b32 v10, 4, v0
    v_and_b32 v11, 7, v0
    v_xor_b32 v11, v11, v10
    v_xor_b32 v11, s9, v11
    v_lshl_add_u32 v2, v11, 4, v9
    s_lshl2_add_u32 s11, s23, s11
    s_lshl_b32 s11, s11, 10
    s_and_b32 s100, s2, 16
    s_mulk_i32 s100, 896
    s_lshl_b32 s7, s23, 3
    v_add_u32 v9, s7, v10
    v_mul_u32_u24 v9, 3584, v9
    v_and_b32 v11, 15, v0
    v_lshlrev_b32 v12, 2, v10
    v_xor_b32 v11, v11, v12
    v_lshl_add_u32 v9, v11, 4, v9
    s_lshl_b32 s7, s5, 8
    v_add_u32 v4, s7, v9
    s_and_b32 s7, s2, 32
    v_xor_b32 v4, s7, v4
    s_and_b32 s7, s8, 3
    s_lshl2_add_u32 s12, s23, s7
    s_lshl_b32 s12, s12, 10
    s_mov_b32 s50, 1605632
    s_mov_b32 s51, s43
    s_mov_b64 s[54:55], s[50:51]
    s_and_b32 s7, s8, 4
    s_and_b32 s9, s8, 2
    s_lshl2_add_u32 s10, s7, s9
    s_mul_i32 s96, s10, 7168
    s_waitcnt lgkmcnt(0)
    s_xor_b32 m0, s11, 0
    s_add_u32 s7, s100, 0
    buffer_load_dwordx4 v2, s[40:43], s7 offen lds
    s_xor_b32 m0, s12, 65536
    s_add_u32 s7, s96, 0
    buffer_load_dwordx4 v4, s[48:51], s7 offen lds
    s_xor_b32 s101, s100, 14336
    s_bitcmp1_b32 s2, 3
    s_cselect_b32 s9, -1, 1
    s_mulk_i32 s9, 7168
    s_xor_b32 m0, s11, 16384
    s_add_u32 s7, s100, 128
    buffer_load_dwordx4 v2, s[40:43], s7 offen lds
    v_xor_b32 v3, 64, v2
    v_add_u32 v3, s9, v3
    v_xor_b32 v5, 32, v4
    s_xor_b32 m0, s12, 98304
    s_add_u32 s7, s96, 229376
    buffer_load_dwordx4 v4, s[48:51], s7 offen lds
    s_xor_b32 s97, s10, 2
    s_mulk_i32 s97, 7168
    s_xor_b32 s98, s10, 16
    s_mulk_i32 s98, 7168
    s_xor_b32 s99, s10, 18
    s_mulk_i32 s99, 7168
    s_xor_b32 m0, s11, 1024
    s_add_u32 s7, s100, 0
    buffer_load_dwordx4 v3, s[40:43], s7 offen lds
    s_xor_b32 m0, s11, 2048
    s_add_u32 s7, s101, 0
    buffer_load_dwordx4 v2, s[40:43], s7 offen lds
    s_xor_b32 m0, s11, 3072
    s_add_u32 s7, s101, 0
    buffer_load_dwordx4 v3, s[40:43], s7 offen lds
    s_xor_b32 m0, s12, 66560
    s_add_u32 s7, s96, 0
    buffer_load_dwordx4 v5, s[52:55], s7 offen lds
    s_xor_b32 m0, s12, 67584
    s_add_u32 s7, s97, 0
    buffer_load_dwordx4 v4, s[48:51], s7 offen lds
    s_load_dwordx2 s[44:45], s[0:1], 8
    s_load_dwordx2 s[68:69], s[0:1], 88
    s_lshr_b32 s3, s3, 6
    s_bitcmp1_b32 s2, 2
    s_cselect_b32 s9, 15, 14
    s_mov_b32 s85, 0x67543210
    s_cselect_b32 s85, 0x9ba8fedc, s85
    s_lshl_b32 s10, s21, 2
    s_lshr_b32 s85, s85, s10
    s_and_b32 s85, s85, 15
    s_mov_b32 s46, 401408
    s_mov_b32 s47, s43
    s_mov_b32 s70, 16777216
    s_mov_b32 s71, s43
    v_lshlrev_b32 v8, 4, v0
    v_mov_b32 v7, 9699328
    s_lshl_b32 s14, s23, 12
    s_add_u32 s81, s5, s8
    s_and_b32 s81, s81, 3
    s_add_u32 s81, s81, 3
    s_mov_b32 s79, s81
    s_lshl_b32 s9, s23, 4
    v_lshrrev_b32 v9, 2, v0
    v_add_u32 v12, s9, v9
    v_mul_u32_u24 v9, 896, v12
    v_and_b32 v11, 3, v0
    v_lshl_add_u32 v6, v11, 4, v9
    s_mul_i32 s9, s85, 56
    v_add_u32 v6, s9, v6
    s_lshl_b32 s13, s23, 10
    v_add_u32 v44, s13, v8
    v_and_b32 v9, 1, v0
    v_lshlrev_b32 v9, 4, v9
    v_mov_b32 v10, 0x3f80
    v_lshlrev_b32 v9, v9, v10
    v_bfe_u32 v10, v0, 1, 3
    v_cmp_eq_u32 vcc, 0, v10
    s_nop 1
    v_cndmask_b32 v16, 0, v9, vcc
    v_cmp_eq_u32 vcc, 1, v10
    s_nop 1
    v_cndmask_b32 v17, 0, v9, vcc
    v_cmp_eq_u32 vcc, 2, v10
    s_nop 1
    v_cndmask_b32 v18, 0, v9, vcc
    v_cmp_eq_u32 vcc, 3, v10
    s_nop 1
    v_cndmask_b32 v19, 0, v9, vcc
    s_lshl2_add_u32 s7, s23, 28672
    v_lshrrev_b32 v9, 4, v0
    v_lshl_add_u32 v45, v9, 7, s7
    v_and_b32 v9, 7, v0
    v_lshl_add_u32 v45, v9, 4, v45
    v_bfe_u32 v9, v0, 3, 1
    v_lshl_add_u32 v45, v9, 9, v45
    v_and_b32 v9, 31, v0
    v_lshlrev_b32 v46, 4, v9
    v_lshrrev_b32 v11, 5, v0
    v_xor_b32 v10, v10, v11
    v_lshlrev_b32 v9, 7, v9
    v_lshl_add_u32 v9, v10, 4, v9
    v_add_u32 v100, s14, v9
    v_xor_b32 v101, 32, v100
    v_xor_b32 v102, 64, v100
    v_xor_b32 v103, 96, v100
    v_lshlrev_b32 v28, 9, v11
    v_bfe_u32 v9, v0, 2, 2
    v_lshl_add_u32 v28, v9, 6, v28
    v_bfe_u32 v10, v0, 4, 1
    v_lshl_add_u32 v28, v10, 5, v28
    v_and_b32 v9, 3, v0
    v_lshl_add_u32 v28, v9, 3, v28
    v_and_b32 v29, 15, v0
    v_lshl_add_u32 v29, v29, 1, v10
    v_lshlrev_b32 v29, 7, v29
    s_add_u32 s73, s14, 9715712
    s_lshl2_add_u32 s72, s4, s23
    s_lshl_b32 s72, s72, 9
    s_add_u32 s72, s72, 9732096
    s_mov_b32 s76, 53248
    s_mov_b32 s77, 65312
    s_mov_b32 s90, 1
    s_xor_b32 m0, s12, 68608
    s_add_u32 s7, s97, 0
    buffer_load_dwordx4 v5, s[52:55], s7 offen lds
    s_xor_b32 m0, s12, 81920
    s_add_u32 s7, s98, 0
    buffer_load_dwordx4 v4, s[48:51], s7 offen lds
    s_xor_b32 m0, s12, 82944
    s_add_u32 s7, s98, 0
    buffer_load_dwordx4 v5, s[52:55], s7 offen lds
    s_xor_b32 m0, s12, 83968
    s_add_u32 s7, s99, 0
    buffer_load_dwordx4 v4, s[48:51], s7 offen lds
    s_xor_b32 m0, s12, 84992
    s_add_u32 s7, s99, 0
    buffer_load_dwordx4 v5, s[52:55], s7 offen lds
    s_waitcnt lgkmcnt(0)
    buffer_load_dword v7, v7, s[68:71], 0 offen sc1
    s_xor_b32 m0, s11, 17408
    s_add_u32 s7, s100, 128
    buffer_load_dwordx4 v3, s[40:43], s7 offen lds
    s_xor_b32 m0, s11, 18432
    s_add_u32 s7, s101, 128
    buffer_load_dwordx4 v2, s[40:43], s7 offen lds
    s_xor_b32 m0, s11, 19456
    s_add_u32 s7, s101, 128
    buffer_load_dwordx4 v3, s[40:43], s7 offen lds
    s_waitcnt vmcnt(8)
    s_barrier
    ds_read_b128 v[108:111], v100 offset:0
    ds_read_b128 v[112:115], v101 offset:0
    ds_read_b128 v[116:119], v102 offset:0
    ds_read_b128 v[120:123], v103 offset:0
    s_xor_b32 m0, s12, 99328
    s_add_u32 s7, s96, 229376
    buffer_load_dwordx4 v5, s[52:55], s7 offen lds
    s_xor_b32 m0, s12, 100352
    s_add_u32 s7, s97, 229376
    buffer_load_dwordx4 v4, s[48:51], s7 offen lds
    s_xor_b32 m0, s12, 101376
    s_add_u32 s7, s97, 229376
    buffer_load_dwordx4 v5, s[52:55], s7 offen lds
    s_xor_b32 m0, s12, 114688
    s_add_u32 s7, s98, 229376
    buffer_load_dwordx4 v4, s[48:51], s7 offen lds
    s_waitcnt vmcnt(8)
    s_barrier
    s_xor_b32 m0, s12, 115712
    s_add_u32 s7, s98, 229376
    buffer_load_dwordx4 v5, s[52:55], s7 offen lds
    s_xor_b32 m0, s12, 116736
    s_add_u32 s7, s99, 229376
    buffer_load_dwordx4 v4, s[48:51], s7 offen lds
    s_xor_b32 m0, s12, 117760
    s_add_u32 s7, s99, 229376
    buffer_load_dwordx4 v5, s[52:55], s7 offen lds
    s_xor_b32 m0, s11, 32768
    s_add_u32 s7, s100, 256
    buffer_load_dwordx4 v2, s[40:43], s7 offen lds
    s_xor_b32 m0, s12, 131072
    s_add_u32 s7, s96, 458752
    buffer_load_dwordx4 v4, s[48:51], s7 offen lds
    s_xor_b32 m0, s11, 33792
    s_add_u32 s7, s100, 256
    buffer_load_dwordx4 v3, s[40:43], s7 offen lds
    s_xor_b32 m0, s11, 34816
    s_add_u32 s7, s101, 256
    buffer_load_dwordx4 v2, s[40:43], s7 offen lds
    s_xor_b32 m0, s11, 35840
    s_add_u32 s7, s101, 256
    buffer_load_dwordx4 v3, s[40:43], s7 offen lds
    s_xor_b32 m0, s12, 132096
    s_add_u32 s7, s96, 458752
    buffer_load_dwordx4 v5, s[52:55], s7 offen lds
    s_xor_b32 m0, s12, 133120
    s_add_u32 s7, s97, 458752
    buffer_load_dwordx4 v4, s[48:51], s7 offen lds
    s_xor_b32 m0, s12, 134144
    s_add_u32 s7, s97, 458752
    buffer_load_dwordx4 v5, s[52:55], s7 offen lds
    s_waitcnt vmcnt(8) lgkmcnt(0)
    v_readfirstlane_b32 s6, v7
    s_mul_i32 s6, s6, 0x9E3779B1
    s_add_u32 s6, s6, 0x7F4A7C15
    s_barrier
    ds_read_b128 v[124:127], v100 offset:16384
    ds_read_b128 v[128:131], v101 offset:16384
    ds_read_b128 v[132:135], v102 offset:16384
    ds_read_b128 v[136:139], v103 offset:16384
    s_xor_b32 m0, s12, 147456
    s_add_u32 s7, s98, 458752
    buffer_load_dwordx4 v4, s[48:51], s7 offen lds
    s_xor_b32 m0, s12, 148480
    s_add_u32 s7, s98, 458752
    buffer_load_dwordx4 v5, s[52:55], s7 offen lds
    s_xor_b32 m0, s12, 149504
    s_add_u32 s7, s99, 458752
    buffer_load_dwordx4 v4, s[48:51], s7 offen lds
    s_xor_b32 m0, s12, 150528
    s_add_u32 s7, s99, 458752
    buffer_load_dwordx4 v5, s[52:55], s7 offen lds
    s_add_u32 m0, s13, 49152
    s_mov_b32 s7, 0
    buffer_load_dwordx4 v6, s[44:47], s7 offen lds
    s_add_u32 m0, s13, 53248
    s_mov_b32 s7, 57344
    buffer_load_dwordx4 v6, s[44:47], s7 offen lds
    s_add_u32 m0, s13, 57344
    s_mov_b32 s7, 114688
    buffer_load_dwordx4 v6, s[44:47], s7 offen lds
    s_lshl_b32 s82, s81, 7
    s_mul_i32 s83, s81, 229376
    s_add_u32 s81, s81, 1
    s_cmp_eq_u32 s81, 7
    s_cselect_b32 s81, 3, s81
    s_xor_b32 m0, s11, 0
    s_add_u32 s7, s100, s82
    buffer_load_dwordx4 v2, s[40:43], s7 offen lds
    s_xor_b32 m0, s11, 1024
    s_add_u32 s7, s100, s82
    buffer_load_dwordx4 v3, s[40:43], s7 offen lds
    s_xor_b32 m0, s11, 2048
    s_add_u32 s7, s101, s82
    buffer_load_dwordx4 v2, s[40:43], s7 offen lds
    s_xor_b32 m0, s11, 3072
    s_add_u32 s7, s101, s82
    buffer_load_dwordx4 v3, s[40:43], s7 offen lds
    s_xor_b32 m0, s12, 65536
    s_add_u32 s7, s96, s83
    buffer_load_dwordx4 v4, s[48:51], s7 offen lds
    s_xor_b32 m0, s12, 66560
    s_add_u32 s7, s96, s83
    buffer_load_dwordx4 v5, s[52:55], s7 offen lds
    s_xor_b32 m0, s12, 67584
    s_add_u32 s7, s97, s83
    buffer_load_dwordx4 v4, s[48:51], s7 offen lds
    s_xor_b32 m0, s12, 68608
    s_add_u32 s7, s97, s83
    buffer_load_dwordx4 v5, s[52:55], s7 offen lds
    s_waitcnt vmcnt(8) lgkmcnt(0)
    s_barrier
    ds_read_b128 v[140:143], v100 offset:32768
    ds_read_b128 v[144:147], v101 offset:32768
    ds_read_b128 v[148:151], v102 offset:32768
    ds_read_b128 v[152:155], v103 offset:32768
    s_setprio 1
    ds_read_b64_tr_b16 v[68:69], v28 offset:49152
    ds_read_b64_tr_b16 v[70:71], v28 offset:49408
    ds_read_b64_tr_b16 v[72:73], v28 offset:50176
    ds_read_b64_tr_b16 v[74:75], v28 offset:50432
    ds_read_b64_tr_b16 v[76:77], v28 offset:51200
    ds_read_b64_tr_b16 v[78:79], v28 offset:51456
    ds_read_b64_tr_b16 v[80:81], v28 offset:52224
    ds_read_b64_tr_b16 v[82:83], v28 offset:52480
    s_waitcnt lgkmcnt(6)
    v_mfma_f32_32x32x16_bf16 v[84:99], v[68:71], v[108:111], 0
    ds_read_b64_tr_b16 v[68:69], v28 offset:53248
    ds_read_b64_tr_b16 v[70:71], v28 offset:53504
    s_waitcnt lgkmcnt(6)
    v_mfma_f32_32x32x16_bf16 v[84:99], v[72:75], v[112:115], v[84:99]
    ds_read_b64_tr_b16 v[72:73], v28 offset:54272
    ds_read_b64_tr_b16 v[74:75], v28 offset:54528
    s_waitcnt lgkmcnt(6)
    v_mfma_f32_32x32x16_bf16 v[84:99], v[76:79], v[116:119], v[84:99]
    ds_read_b64_tr_b16 v[76:77], v28 offset:55296
    ds_read_b64_tr_b16 v[78:79], v28 offset:55552
    s_waitcnt lgkmcnt(6)
    v_mfma_f32_32x32x16_bf16 v[84:99], v[80:83], v[120:123], v[84:99]
    ds_read_b64_tr_b16 v[80:81], v28 offset:56320
    ds_read_b64_tr_b16 v[82:83], v28 offset:56576
    s_waitcnt lgkmcnt(6)
    v_mfma_f32_32x32x16_bf16 v[84:99], v[68:71], v[124:127], v[84:99]
    ds_read_b64_tr_b16 v[68:69], v28 offset:57344
    ds_read_b64_tr_b16 v[70:71], v28 offset:57600
    s_waitcnt lgkmcnt(6)
    v_mfma_f32_32x32x16_bf16 v[84:99], v[72:75], v[128:131], v[84:99]
    ds_read_b128 v[48:51], v44 offset:49152
    ds_read_b128 v[52:55], v44 offset:53248
    ds_read_b128 v[56:59], v44 offset:57344
    ds_read_b64_tr_b16 v[72:73], v28 offset:58368
    ds_read_b64_tr_b16 v[74:75], v28 offset:58624
    s_waitcnt lgkmcnt(9)
    v_mfma_f32_32x32x16_bf16 v[84:99], v[76:79], v[132:135], v[84:99]
    ds_read_b64_tr_b16 v[76:77], v28 offset:59392
    ds_read_b64_tr_b16 v[78:79], v28 offset:59648
    s_waitcnt lgkmcnt(9)
    v_mfma_f32_32x32x16_bf16 v[84:99], v[80:83], v[136:139], v[84:99]
    ds_read_b64_tr_b16 v[80:81], v28 offset:60416
    ds_read_b64_tr_b16 v[82:83], v28 offset:60672
    s_waitcnt lgkmcnt(9)
    v_mfma_f32_32x32x16_bf16 v[84:99], v[68:71], v[140:143], v[84:99]
    s_waitcnt lgkmcnt(4)
    v_mfma_f32_32x32x16_bf16 v[84:99], v[72:75], v[144:147], v[84:99]
    s_waitcnt lgkmcnt(2)
    v_mfma_f32_32x32x16_bf16 v[84:99], v[76:79], v[148:151], v[84:99]
    s_waitcnt lgkmcnt(0)
    v_mfma_f32_32x32x16_bf16 v[84:99], v[80:83], v[152:155], v[84:99]
    s_waitcnt lgkmcnt(6)
    v_mfma_f32_16x16x32_bf16 v[32:35], v[48:51], v[16:19], 0
    v_mfma_f32_16x16x32_bf16 v[32:35], v[52:55], v[16:19], v[32:35]
    v_mfma_f32_16x16x32_bf16 v[32:35], v[56:59], v[16:19], v[32:35]
    s_xor_b32 m0, s12, 81920
    s_add_u32 s7, s98, s83
    buffer_load_dwordx4 v4, s[48:51], s7 offen lds
    s_xor_b32 m0, s12, 82944
    s_add_u32 s7, s98, s83
    buffer_load_dwordx4 v5, s[52:55], s7 offen lds
    s_xor_b32 m0, s12, 83968
    s_add_u32 s7, s99, s83
    buffer_load_dwordx4 v4, s[48:51], s7 offen lds
    s_xor_b32 m0, s12, 84992
    s_add_u32 s7, s99, s83
    buffer_load_dwordx4 v5, s[52:55], s7 offen lds
    s_add_u32 m0, s13, 61440
    s_mul_i32 s7, s79, 57344
    buffer_load_dwordx4 v6, s[44:47], s7 offen lds
    s_add_u32 s79, s79, 1
    s_cmp_eq_u32 s79, 7
    s_cselect_b32 s79, 3, s79
    s_lshl_b32 s82, s81, 7
    s_mul_i32 s83, s81, 229376
    s_add_u32 s81, s81, 1
    s_cmp_eq_u32 s81, 7
    s_cselect_b32 s81, 3, s81
    s_xor_b32 m0, s11, 16384
    s_add_u32 s7, s100, s82
    buffer_load_dwordx4 v2, s[40:43], s7 offen lds
    s_xor_b32 m0, s11, 17408
    s_add_u32 s7, s100, s82
    buffer_load_dwordx4 v3, s[40:43], s7 offen lds
    s_xor_b32 m0, s11, 18432
    s_add_u32 s7, s101, s82
    buffer_load_dwordx4 v2, s[40:43], s7 offen lds
    s_xor_b32 m0, s11, 19456
    s_add_u32 s7, s101, s82
    buffer_load_dwordx4 v3, s[40:43], s7 offen lds
    s_xor_b32 m0, s12, 98304
    s_add_u32 s7, s96, s83
    buffer_load_dwordx4 v4, s[48:51], s7 offen lds
    s_xor_b32 m0, s12, 99328
    s_add_u32 s7, s96, s83
    buffer_load_dwordx4 v5, s[52:55], s7 offen lds
    s_xor_b32 m0, s12, 100352
    s_add_u32 s7, s97, s83
    buffer_load_dwordx4 v4, s[48:51], s7 offen lds
    s_xor_b32 m0, s12, 101376
    s_add_u32 s7, s97, s83
    buffer_load_dwordx4 v5, s[52:55], s7 offen lds
    s_xor_b32 m0, s12, 114688
    s_add_u32 s7, s98, s83
    buffer_load_dwordx4 v4, s[48:51], s7 offen lds
    s_setprio 0
    s_waitcnt vmcnt(9) lgkmcnt(0)
    s_barrier
    ds_read_b128 v[156:159], v100 offset:0
    ds_read_b128 v[160:163], v101 offset:0
    ds_read_b128 v[164:167], v102 offset:0
    ds_read_b128 v[168:171], v103 offset:0
    s_setprio 1
    ds_read_b64_tr_b16 v[68:69], v28 offset:61440
    ds_read_b64_tr_b16 v[70:71], v28 offset:61696
    ds_read_b64_tr_b16 v[72:73], v28 offset:62464
    ds_read_b64_tr_b16 v[74:75], v28 offset:62720
    ds_read_b64_tr_b16 v[76:77], v28 offset:63488
    ds_read_b64_tr_b16 v[78:79], v28 offset:63744
    s_xor_b32 m0, s12, 115712
    s_add_u32 s7, s98, s83
    buffer_load_dwordx4 v5, s[52:55], s7 offen lds
    ds_read_b128 v[60:63], v44 offset:61440
    s_xor_b32 m0, s12, 116736
    s_add_u32 s7, s99, s83
    buffer_load_dwordx4 v4, s[48:51], s7 offen lds
    ds_read_b64_tr_b16 v[80:81], v28 offset:64512
    ds_read_b64_tr_b16 v[82:83], v28 offset:64768
    s_waitcnt lgkmcnt(7)
    v_mfma_f32_32x32x16_bf16 v[84:99], v[68:71], v[156:159], v[84:99]
    s_xor_b32 m0, s12, 117760
    s_add_u32 s7, s99, s83
    buffer_load_dwordx4 v5, s[52:55], s7 offen lds
    s_add_u32 m0, s13, 49152
    s_mul_i32 s7, s79, 57344
    buffer_load_dwordx4 v6, s[44:47], s7 offen lds
    s_add_u32 s79, s79, 1
    s_cmp_eq_u32 s79, 7
    s_cselect_b32 s79, 3, s79
    s_add_u32 m0, s13, 53248
    s_mul_i32 s7, s79, 57344
    buffer_load_dwordx4 v6, s[44:47], s7 offen lds
    s_add_u32 s79, s79, 1
    s_cmp_eq_u32 s79, 7
    s_cselect_b32 s79, 3, s79
    s_waitcnt lgkmcnt(5)
    v_mfma_f32_32x32x16_bf16 v[84:99], v[72:75], v[160:163], v[84:99]
    s_lshl_b32 s82, s81, 7
    s_mul_i32 s83, s81, 229376
    s_add_u32 s81, s81, 1
    s_cmp_eq_u32 s81, 7
    s_cselect_b32 s81, 3, s81
    s_xor_b32 m0, s11, 32768
    s_add_u32 s7, s100, s82
    buffer_load_dwordx4 v2, s[40:43], s7 offen lds
    s_xor_b32 m0, s11, 33792
    s_add_u32 s7, s100, s82
    buffer_load_dwordx4 v3, s[40:43], s7 offen lds
    s_xor_b32 m0, s11, 34816
    s_add_u32 s7, s101, s82
    buffer_load_dwordx4 v2, s[40:43], s7 offen lds
    s_waitcnt lgkmcnt(2)
    v_mfma_f32_16x16x32_bf16 v[32:35], v[60:63], v[16:19], v[32:35]
    s_waitcnt lgkmcnt(3)
    v_mfma_f32_32x32x16_bf16 v[84:99], v[76:79], v[164:167], v[84:99]
    s_xor_b32 m0, s11, 35840
    s_add_u32 s7, s101, s82
    buffer_load_dwordx4 v3, s[40:43], s7 offen lds
    s_xor_b32 m0, s12, 131072
    s_add_u32 s7, s96, s83
    buffer_load_dwordx4 v4, s[48:51], s7 offen lds
    s_xor_b32 m0, s12, 132096
    s_add_u32 s7, s96, s83
    buffer_load_dwordx4 v5, s[52:55], s7 offen lds
    s_waitcnt lgkmcnt(0)
    v_mfma_f32_32x32x16_bf16 v[84:99], v[80:83], v[168:171], v[84:99]
    s_xor_b32 m0, s12, 133120
    s_add_u32 s7, s97, s83
    buffer_load_dwordx4 v4, s[48:51], s7 offen lds
    s_xor_b32 m0, s12, 134144
    s_add_u32 s7, s97, s83
    buffer_load_dwordx4 v5, s[52:55], s7 offen lds
    s_xor_b32 m0, s12, 147456
    s_add_u32 s7, s98, s83
    buffer_load_dwordx4 v4, s[48:51], s7 offen lds
    s_setprio 0
    s_waitcnt vmcnt(10) lgkmcnt(0)
    s_barrier
    ds_read_b128 v[172:175], v100 offset:16384
    ds_read_b128 v[176:179], v101 offset:16384
    ds_read_b128 v[180:183], v102 offset:16384
    ds_read_b128 v[184:187], v103 offset:16384
    s_setprio 1
    ds_read_b64_tr_b16 v[68:69], v28 offset:49152
    ds_read_b64_tr_b16 v[70:71], v28 offset:49408
    ds_read_b64_tr_b16 v[72:73], v28 offset:50176
    ds_read_b64_tr_b16 v[74:75], v28 offset:50432
    ds_read_b64_tr_b16 v[76:77], v28 offset:51200
    ds_read_b64_tr_b16 v[78:79], v28 offset:51456
    buffer_load_dwordx3 v[188:190], v46, s[68:71], s72 offen sc1
    ds_read_b128 v[64:67], v44 offset:49152
    s_xor_b32 m0, s12, 148480
    s_add_u32 s7, s98, s83
    buffer_load_dwordx4 v5, s[52:55], s7 offen lds
    ds_read_b64_tr_b16 v[80:81], v28 offset:52224
    ds_read_b64_tr_b16 v[82:83], v28 offset:52480
    s_waitcnt lgkmcnt(7)
    v_mfma_f32_32x32x16_bf16 v[84:99], v[68:71], v[172:175], v[84:99]
    s_xor_b32 m0, s12, 149504
    s_add_u32 s7, s99, s83
    buffer_load_dwordx4 v4, s[48:51], s7 offen lds
    s_xor_b32 m0, s12, 150528
    s_add_u32 s7, s99, s83
    buffer_load_dwordx4 v5, s[52:55], s7 offen lds
    s_add_u32 m0, s13, 57344
    s_mul_i32 s7, s79, 57344
    buffer_load_dwordx4 v6, s[44:47], s7 offen lds
    s_waitcnt lgkmcnt(5)
    v_mfma_f32_32x32x16_bf16 v[84:99], v[72:75], v[176:179], v[84:99]
    s_lshl_b32 s82, s81, 7
    s_mul_i32 s83, s81, 229376
    s_add_u32 s81, s81, 1
    s_cmp_eq_u32 s81, 7
    s_cselect_b32 s81, 3, s81
    s_xor_b32 m0, s11, 0
    s_add_u32 s7, s100, s82
    buffer_load_dwordx4 v2, s[40:43], s7 offen lds
    s_xor_b32 m0, s11, 1024
    s_add_u32 s7, s100, s82
    buffer_load_dwordx4 v3, s[40:43], s7 offen lds
    s_xor_b32 m0, s11, 2048
    s_add_u32 s7, s101, s82
    buffer_load_dwordx4 v2, s[40:43], s7 offen lds
    s_waitcnt lgkmcnt(2)
    v_mfma_f32_16x16x32_bf16 v[32:35], v[64:67], v[16:19], v[32:35]
    s_waitcnt lgkmcnt(3)
    v_mfma_f32_32x32x16_bf16 v[84:99], v[76:79], v[180:183], v[84:99]
    s_xor_b32 m0, s11, 3072
    s_add_u32 s7, s101, s82
    buffer_load_dwordx4 v3, s[40:43], s7 offen lds
    s_xor_b32 m0, s12, 65536
    s_add_u32 s7, s96, s83
    buffer_load_dwordx4 v4, s[48:51], s7 offen lds
    s_xor_b32 m0, s12, 66560
    s_add_u32 s7, s96, s83
    buffer_load_dwordx4 v5, s[52:55], s7 offen lds
    s_waitcnt lgkmcnt(0)
    v_mfma_f32_32x32x16_bf16 v[84:99], v[80:83], v[184:187], v[84:99]
    s_xor_b32 m0, s12, 67584
    s_add_u32 s7, s97, s83
    buffer_load_dwordx4 v4, s[48:51], s7 offen lds
    s_xor_b32 m0, s12, 68608
    s_add_u32 s7, s97, s83
    buffer_load_dwordx4 v5, s[52:55], s7 offen lds
    s_xor_b32 m0, s12, 81920
    s_add_u32 s7, s98, s83
    buffer_load_dwordx4 v4, s[48:51], s7 offen lds
    s_setprio 0
    s_waitcnt vmcnt(9) lgkmcnt(0)
    s_barrier
    ds_read_b128 v[108:111], v100 offset:32768
    ds_read_b128 v[112:115], v101 offset:32768
    ds_read_b128 v[116:119], v102 offset:32768
    ds_read_b128 v[120:123], v103 offset:32768
    s_setprio 1
    ds_read_b64_tr_b16 v[68:69], v28 offset:53248
    ds_read_b64_tr_b16 v[70:71], v28 offset:53504
    ds_read_b64_tr_b16 v[72:73], v28 offset:54272
    ds_read_b64_tr_b16 v[74:75], v28 offset:54528
    ds_read_b64_tr_b16 v[76:77], v28 offset:55296
    ds_read_b64_tr_b16 v[78:79], v28 offset:55552
    s_xor_b32 m0, s12, 82944
    s_add_u32 s7, s98, s83
    buffer_load_dwordx4 v5, s[52:55], s7 offen lds
    ds_read_b128 v[40:43], v44 offset:53248
    ds_read_b128 v[36:39], v44 offset:57344
    ds_read_b64_tr_b16 v[80:81], v28 offset:56320
    ds_read_b64_tr_b16 v[82:83], v28 offset:56576
    s_waitcnt lgkmcnt(8)
    v_mfma_f32_32x32x16_bf16 v[84:99], v[68:71], v[108:111], v[84:99]
    s_xor_b32 m0, s12, 83968
    s_add_u32 s7, s99, s83
    buffer_load_dwordx4 v4, s[48:51], s7 offen lds
    s_waitcnt lgkmcnt(6)
    v_mfma_f32_32x32x16_bf16 v[84:99], v[72:75], v[112:115], v[84:99]
    s_xor_b32 m0, s12, 84992
    s_add_u32 s7, s99, s83
    buffer_load_dwordx4 v5, s[52:55], s7 offen lds
    s_waitcnt lgkmcnt(2)
    v_mfma_f32_16x16x32_bf16 v[32:35], v[40:43], v[16:19], v[32:35]
    v_mfma_f32_16x16x32_bf16 v[32:35], v[36:39], v[16:19], v[32:35]
    s_waitcnt lgkmcnt(4)
    v_mfma_f32_32x32x16_bf16 v[84:99], v[76:79], v[116:119], v[84:99]
    buffer_load_dwordx2 v[48:49], v29, s[68:71], s73 offen offset:0 sc1
    s_waitcnt lgkmcnt(0)
    v_mfma_f32_32x32x16_bf16 v[84:99], v[80:83], v[120:123], v[84:99]
    v_lshlrev_b32 v9, 2, v0
    v_mov_b32 v10, 0
    ds_write_b32 v9, v10 offset:65280
    s_setprio 1
    s_waitcnt vmcnt(9)
    ds_read_b128 v[124:127], v100 offset:0
    ds_read_b128 v[128:131], v101 offset:0
    ds_read_b128 v[132:135], v102 offset:0
    ds_read_b128 v[136:139], v103 offset:0
    ds_read_b64_tr_b16 v[68:69], v28 offset:57344
    ds_read_b64_tr_b16 v[70:71], v28 offset:57600
    ds_read_b64_tr_b16 v[72:73], v28 offset:58368
    ds_read_b64_tr_b16 v[74:75], v28 offset:58624
    ds_read_b64_tr_b16 v[76:77], v28 offset:59392
    ds_read_b64_tr_b16 v[78:79], v28 offset:59648
    s_waitcnt vmcnt(17)
    v_cmp_eq_u32 s[16:17], s6, v190
    v_cmp_eq_u32 vcc, s6, v190
    s_and_b64 s[16:17], s[16:17], vcc
    s_cmp_eq_u64 s[16:17], -1
    s_cbranch_scc0 L_kvretryt
L_kvokt:
    s_lshl_b32 s7, s23, 8
    v_lshl_add_u32 v30, v0, 2, s7
    v_cmp_gt_u32 vcc, 32, v0
    v_mul_f32 v150, 0x3e8b97f6, v189
    ds_write_b32 v30, v188 offset:30720
    ds_read_b64_tr_b16 v[80:81], v28 offset:60416
    ds_read_b64_tr_b16 v[82:83], v28 offset:60672
    s_waitcnt lgkmcnt(7)
    v_mfma_f32_32x32x16_bf16 v[84:99], v[68:71], v[124:127], v[84:99]
    v_permlane32_swap_b32 v32, v34
    v_permlane32_swap_b32 v33, v35
    v_add_f32 v32, v32, v34
    v_add_f32 v33, v33, v35
    v_cndmask_b32 v151, 0, v150, vcc
    v_cndmask_b32 v188, 0, v188, vcc
    s_waitcnt lgkmcnt(5)
    v_mfma_f32_32x32x16_bf16 v[84:99], v[72:75], v[128:131], v[84:99]
    v_permlane16_swap_b32 v32, v33
    v_add_f32 v32, v32, v33
    ds_write_b32 v45, v32
    v_mul_f32 v14, v189, v189
    s_waitcnt lgkmcnt(4)
    v_mfma_f32_32x32x16_bf16 v[84:99], v[76:79], v[132:135], v[84:99]
    v_mov_b32 v189, 0
    v_mov_b32 v190, 0
    v_mov_b32 v191, 0
    v_rcp_f32 v14, v14
    s_waitcnt lgkmcnt(1)
    v_mfma_f32_32x32x16_bf16 v[84:99], v[80:83], v[136:139], v[84:99]
    v_mov_b32 v145, 0
    v_mov_b32 v146, 0
    v_mov_b32 v147, 0
    v_and_b32 v10, 3, v0
    v_mov_b32 v11, 1
    s_waitcnt vmcnt(0)
    v_cmp_eq_u32 s[16:17], s6, v48
    v_cmp_eq_u32 vcc, s6, v48
    s_and_b64 s[16:17], s[16:17], vcc
    s_cmp_eq_u64 s[16:17], -1
    s_cbranch_scc0 L_kvretryl
L_kvokl:
    v_max_f32_dpp v49, v49, v49 row_shr:1 row_mask:0xf bank_mask:0xf bound_ctrl:0
    s_lshl_b32 s79, s23, 16
    s_add_u32 s79, s79, 9433088
    v_max_f32_dpp v49, v49, v49 row_shr:2 row_mask:0xf bank_mask:0xf bound_ctrl:0
    s_add_u32 s72, s68, s79
    s_addc_u32 s73, s69, 0
    v_max_f32_dpp v49, v49, v49 row_shr:4 row_mask:0xf bank_mask:0xf bound_ctrl:0
    s_mov_b32 s74, 4096
    s_mov_b32 s75, 0x20000
    v_max_f32_dpp v49, v49, v49 row_shr:8 row_mask:0xf bank_mask:0xf bound_ctrl:0
    v_lshrrev_b32 v167, 5, v0
    ds_write_b32 v30, v49 offset:29696
    v_lshlrev_b32 v167, 6, v167
    s_add_u32 s72, s72, 4096
    s_addc_u32 s73, s73, 0
    buffer_load_dwordx4 v[192:195], v8, s[72:75], 0 offen offset:0 sc1
    buffer_load_dwordx4 v[196:199], v8, s[72:75], 0 offen offset:1024 sc1
    buffer_load_dwordx4 v[200:203], v8, s[72:75], 0 offen offset:2048 sc1
    buffer_load_dwordx4 v[204:207], v8, s[72:75], 0 offen offset:3072 sc1
    s_waitcnt vmcnt(5) lgkmcnt(0)
    s_barrier
    s_setprio 1
    ds_read_b128 v[140:143], v46 offset:28672
    ds_read_b32 v164, v167 offset:29756
    ds_read_b32 v165, v167 offset:30012
    ds_read_b32 v166, v167 offset:30268
    ds_read_b32 v167, v167 offset:30524
    s_waitcnt lgkmcnt(4)
    v_add_f32 v140, v140, v141
    v_add_f32 v142, v142, v143
    v_add_f32 v140, v140, v142
    v_cvt_pk_bf16_f32 v141, v140, v140
    v_and_b32 v141, 0xffff0000, v141
    v_sub_f32 v140, v140, v141
    v_cvt_pk_bf16_f32 v144, v141, v140
    s_waitcnt lgkmcnt(0)
    v_max3_f32 v164, v164, v165, v166
    v_mfma_f32_32x32x16_bf16 v[84:99], v[144:147], v[188:191], v[84:99]
    s_setprio 3
    s_add_u32 s72, s72, 4096
    s_addc_u32 s73, s73, 0
    buffer_load_dwordx4 v[208:211], v8, s[72:75], 0 offen offset:0 sc1
    buffer_load_dwordx4 v[212:215], v8, s[72:75], 0 offen offset:1024 sc1
    v_max_f32 v164, v164, v167
    buffer_load_dwordx4 v[216:219], v8, s[72:75], 0 offen offset:2048 sc1
    buffer_load_dwordx4 v[220:223], v8, s[72:75], 0 offen offset:3072 sc1
    v_readlane_b32 s93, v164, 0
    v_readlane_b32 s94, v164, 32
    s_nop 0
    s_nop 0
    s_nop 0
    s_nop 0
    s_lshl_b32 s7, s23, 2
    v_lshlrev_b32 v10, 2, v10
    v_mov_b32 v12, s7
    s_lshl_b32 s7, s23, 11
    s_add_u32 s8, s7, s76
    v_add_u32 v160, s8, v8
    v_mul_f32 v84, v150, v84
    v_mul_f32 v85, v150, v85
    v_mul_f32 v86, v150, v86
    v_mul_f32 v87, v150, v87
    v_mul_f32 v88, v150, v88
    v_mul_f32 v89, v150, v89
    v_mul_f32 v90, v150, v90
    v_mul_f32 v91, v150, v91
    v_cvt_pk_bf16_f32 v152, v84, v85
    v_cvt_pk_bf16_f32 v153, v86, v87
    v_cvt_pk_bf16_f32 v154, v88, v89
    v_cvt_pk_bf16_f32 v155, v90, v91
    ds_write_b128 v160, v[152:155] offset:0
    v_mul_f32 v92, v150, v92
    v_mul_f32 v93, v150, v93
    v_mul_f32 v94, v150, v94
    v_mul_f32 v95, v150, v95
    v_mul_f32 v96, v151, v96
    v_mul_f32 v97, v151, v97
    v_mul_f32 v98, v151, v98
    v_mul_f32 v99, v151, v99
    v_cvt_pk_bf16_f32 v156, v92, v93
    v_cvt_pk_bf16_f32 v157, v94, v95
    v_cvt_pk_bf16_f32 v158, v96, v97
    v_cvt_pk_bf16_f32 v159, v98, v99
    ds_write_b128 v160, v[156:159] offset:1024
    v_mul_f32 v161, v84, v84
    v_mul_f32 v162, v85, v85
    v_fmac_f32 v161, v86, v86
    v_fmac_f32 v162, v87, v87
    v_fmac_f32 v161, v88, v88
    v_fmac_f32 v162, v89, v89
    v_fmac_f32 v161, v90, v90
    v_fmac_f32 v162, v91, v91
    v_fmac_f32 v161, v92, v92
    v_fmac_f32 v162, v93, v93
    v_fmac_f32 v161, v94, v94
    v_fmac_f32 v162, v95, v95
    v_fmac_f32 v161, v96, v96
    v_fmac_f32 v162, v97, v97
    v_fmac_f32 v161, v98, v98
    v_fmac_f32 v162, v99, v99
    v_add_f32 v161, v161, v162
    s_lshl2_add_u32 s8, s23, s76
    v_mov_b32 v162, v161
    v_mov_b32 v160, s8
    s_nop 0
    v_permlane32_swap_b32 v161, v162
    v_add_f32 v161, v161, v162
    v_mul_f32 v161, s93, v161
    v_cmp_ge_f32 vcc, 0x45610000, v161
    s_cmp_eq_u64 vcc, -1
    s_cselect_b32 s7, 0, 1
    s_cmp_le_u32 s94, 0x58800000
    s_cselect_b32 s7, s7, 1
    v_mov_b32 v161, s7
    ds_write_b32 v160, v161 offset:10240
    ds_write_b32 v12, v11 offset:65312
    s_add_u32 s72, s72, 4096
    s_addc_u32 s73, s73, 0
    buffer_load_dwordx4 v[224:227], v8, s[72:75], 0 offen offset:0 sc1
    buffer_load_dwordx4 v[228:231], v8, s[72:75], 0 offen offset:1024 sc1
    buffer_load_dwordx4 v[232:235], v8, s[72:75], 0 offen offset:2048 sc1
    buffer_load_dwordx4 v[236:239], v8, s[72:75], 0 offen offset:3072 sc1
    s_add_u32 s72, s72, 4096
    s_addc_u32 s73, s73, 0
    buffer_load_dwordx4 v[240:243], v8, s[72:75], 0 offen offset:0 sc1
    buffer_load_dwordx4 v[244:247], v8, s[72:75], 0 offen offset:1024 sc1
    buffer_load_dwordx4 v[248:251], v8, s[72:75], 0 offen offset:2048 sc1
    buffer_load_dwordx4 v[252:255], v8, s[72:75], 0 offen offset:3072 sc1
    s_mov_b32 s15, 200000
L_qx:
    ds_read_b32 v9, v10 offset:65312
    s_waitcnt lgkmcnt(0)
    v_cmp_gt_u32 vcc, 1, v9
    s_cbranch_vccz L_qx_ok
    s_sub_u32 s15, s15, 1
    s_cbranch_scc0 L_qx
L_qx_ok:
L_attn:
    v_mov_b32 v161, s76
    s_add_u32 s7, s23, 1
    s_and_b32 s7, s7, 3
    s_lshl_b32 s7, s7, 11
    s_add_u32 s7, s7, s76
    v_add_u32 v160, s7, v8
    ds_read_b128 v[164:167], v161 offset:10240
    ds_read_b128 v[16:19], v160
    ds_read_b128 v[20:23], v160 offset:1024
    s_add_u32 s7, s23, 2
    s_and_b32 s7, s7, 3
    s_lshl_b32 s7, s7, 11
    s_add_u32 s7, s7, s76
    v_add_u32 v160, s7, v8
    ds_read_b128 v[24:27], v160
    ds_read_b128 v[28:31], v160 offset:1024
    s_add_u32 s7, s23, 3
    s_and_b32 s7, s7, 3
    s_lshl_b32 s7, s7, 11
    s_add_u32 s7, s7, s76
    v_add_u32 v160, s7, v8
    ds_read_b128 v[32:35], v160
    ds_read_b128 v[36:39], v160 offset:1024
    s_add_u32 s7, s23, 4
    s_and_b32 s7, s7, 3
    s_lshl_b32 s7, s7, 11
    s_add_u32 s7, s7, s76
    v_add_u32 v160, s7, v8
    ds_read_b128 v[40:43], v160
    ds_read_b128 v[44:47], v160 offset:1024
    s_waitcnt lgkmcnt(8)
    v_or3_b32 v164, v164, v165, v166
    v_or_b32 v164, v164, v167
    v_cmp_ne_u32 vcc, 0, v164
    s_waitcnt lgkmcnt(0)
    s_cbranch_vccnz L_slow
L_fast:
    s_setprio 1
    s_waitcnt vmcnt(14)
    v_mfma_f32_32x32x16_bf16 v[112:127], v[192:195], v[16:19], 0
    v_mfma_f32_32x32x16_bf16 v[112:127], v[196:199], v[20:23], v[112:127]
    s_nop 1
    s_mov_b32 s78, 1
    s_add_u32 s7, s23, 1
    s_and_b32 s7, s7, 3
    s_mul_i32 s7, s7, 12288
    v_add_u32 v168, s7, v8
    s_add_u32 s7, s23, 2
    s_and_b32 s7, s7, 3
    s_mul_i32 s7, s7, 12288
    v_add_u32 v169, s7, v8
    s_add_u32 s7, s23, 3
    s_and_b32 s7, s7, 3
    s_mul_i32 s7, s7, 12288
    v_add_u32 v170, s7, v8
    s_add_u32 s7, s23, 4
    s_and_b32 s7, s7, 3
    s_mul_i32 s7, s7, 12288
    v_add_u32 v171, s7, v8
    s_lshl2_add_u32 s7, s23, s77
    v_and_b32 v173, 3, v0
    v_mov_b32 v172, s7
    v_lshl_add_u32 v173, v173, 2, s77
    v_mov_b32 v174, 2
    v_mov_b32 v175, 3
    v_mov_b32 v15, v14
    v_mfma_f32_32x32x16_bf16 v[128:143], v[192:195], v[24:27], 0
    v_exp_f32 v112, v112
    v_exp_f32 v113, v113
    v_exp_f32 v114, v114
    v_mfma_f32_32x32x16_bf16 v[128:143], v[196:199], v[28:31], v[128:143]
    v_exp_f32 v115, v115
    v_exp_f32 v116, v116
    v_exp_f32 v117, v117
    v_exp_f32 v118, v118
    v_exp_f32 v119, v119
    v_exp_f32 v120, v120
    v_exp_f32 v121, v121
    v_exp_f32 v122, v122
    v_exp_f32 v123, v123
    v_cvt_pk_bf16_f32 v144, v112, v113
    v_cvt_pk_bf16_f32 v145, v114, v115
    v_cvt_pk_bf16_f32 v146, v116, v117
    v_cvt_pk_bf16_f32 v147, v118, v119
    v_exp_f32 v124, v124
    v_exp_f32 v125, v125
    v_exp_f32 v126, v126
    v_exp_f32 v127, v127
    v_cvt_pk_bf16_f32 v148, v120, v121
    v_cvt_pk_bf16_f32 v149, v122, v123
    v_cvt_pk_bf16_f32 v150, v124, v125
    v_cvt_pk_bf16_f32 v151, v126, v127
    v_mfma_f32_32x32x16_bf16 v[112:127], v[192:195], v[32:35], 0
    s_waitcnt vmcnt(12)
    v_exp_f32 v128, v128
    v_exp_f32 v129, v129
    v_exp_f32 v130, v130
    v_mfma_f32_32x32x16_bf16 v[112:127], v[196:199], v[36:39], v[112:127]
    v_exp_f32 v131, v131
    v_exp_f32 v132, v132
    v_exp_f32 v133, v133
    v_mfma_f32_32x32x16_bf16 v[48:63], v[200:203], v[144:147], 0
    v_exp_f32 v134, v134
    v_exp_f32 v135, v135
    v_exp_f32 v136, v136
    v_mfma_f32_32x32x16_bf16 v[48:63], v[204:207], v[148:151], v[48:63]
    v_exp_f32 v137, v137
    v_exp_f32 v138, v138
    v_exp_f32 v139, v139
    v_cvt_pk_bf16_f32 v152, v128, v129
    v_cvt_pk_bf16_f32 v153, v130, v131
    v_cvt_pk_bf16_f32 v154, v132, v133
    v_cvt_pk_bf16_f32 v155, v134, v135
    v_exp_f32 v140, v140
    v_exp_f32 v141, v141
    v_exp_f32 v142, v142
    v_exp_f32 v143, v143
    v_cvt_pk_bf16_f32 v156, v136, v137
    v_cvt_pk_bf16_f32 v157, v138, v139
    v_cvt_pk_bf16_f32 v158, v140, v141
    v_cvt_pk_bf16_f32 v159, v142, v143
    v_mfma_f32_32x32x16_bf16 v[128:143], v[192:195], v[40:43], 0
    v_exp_f32 v112, v112
    v_exp_f32 v113, v113
    v_exp_f32 v114, v114
    v_mfma_f32_32x32x16_bf16 v[128:143], v[196:199], v[44:47], v[128:143]
    v_exp_f32 v115, v115
    v_exp_f32 v116, v116
    v_exp_f32 v117, v117
    v_mfma_f32_32x32x16_bf16 v[64:79], v[200:203], v[152:155], 0
    s_waitcnt vmcnt(10)
    v_exp_f32 v118, v118
    v_exp_f32 v119, v119
    v_exp_f32 v120, v120
    v_mfma_f32_32x32x16_bf16 v[64:79], v[204:207], v[156:159], v[64:79]
    v_exp_f32 v121, v121
    v_exp_f32 v122, v122
    v_exp_f32 v123, v123
    v_cvt_pk_bf16_f32 v144, v112, v113
    v_cvt_pk_bf16_f32 v145, v114, v115
    v_cvt_pk_bf16_f32 v146, v116, v117
    v_cvt_pk_bf16_f32 v147, v118, v119
    v_exp_f32 v124, v124
    v_exp_f32 v125, v125
    v_exp_f32 v126, v126
    v_exp_f32 v127, v127
    v_cvt_pk_bf16_f32 v148, v120, v121
    v_cvt_pk_bf16_f32 v149, v122, v123
    v_cvt_pk_bf16_f32 v150, v124, v125
    v_cvt_pk_bf16_f32 v151, v126, v127
    v_mfma_f32_32x32x16_bf16 v[112:127], v[208:211], v[16:19], 0
    s_add_u32 s72, s72, 4096
    v_exp_f32 v128, v128
    v_exp_f32 v129, v129
    v_exp_f32 v130, v130
    v_mfma_f32_32x32x16_bf16 v[112:127], v[212:215], v[20:23], v[112:127]
    s_addc_u32 s73, s73, 0
    v_exp_f32 v131, v131
    v_exp_f32 v132, v132
    v_exp_f32 v133, v133
    v_mfma_f32_32x32x16_bf16 v[80:95], v[200:203], v[144:147], 0
    v_exp_f32 v134, v134
    v_exp_f32 v135, v135
    v_exp_f32 v136, v136
    v_mfma_f32_32x32x16_bf16 v[80:95], v[204:207], v[148:151], v[80:95]
    buffer_load_dwordx4 v[192:195], v8, s[72:75], 0 offen offset:0 sc1
    buffer_load_dwordx4 v[196:199], v8, s[72:75], 0 offen offset:1024 sc1
    v_exp_f32 v137, v137
    v_exp_f32 v138, v138
    v_exp_f32 v139, v139
    v_cvt_pk_bf16_f32 v152, v128, v129
    v_cvt_pk_bf16_f32 v153, v130, v131
    v_cvt_pk_bf16_f32 v154, v132, v133
    v_cvt_pk_bf16_f32 v155, v134, v135
    v_exp_f32 v140, v140
    v_exp_f32 v141, v141
    v_exp_f32 v142, v142
    v_exp_f32 v143, v143
    v_cvt_pk_bf16_f32 v156, v136, v137
    v_cvt_pk_bf16_f32 v157, v138, v139
    v_cvt_pk_bf16_f32 v158, v140, v141
    v_cvt_pk_bf16_f32 v159, v142, v143
    v_mfma_f32_32x32x16_bf16 v[128:143], v[208:211], v[24:27], 0
    v_exp_f32 v112, v112
    v_exp_f32 v113, v113
    v_exp_f32 v114, v114
    v_mfma_f32_32x32x16_bf16 v[128:143], v[212:215], v[28:31], v[128:143]
    v_exp_f32 v115, v115
    v_exp_f32 v116, v116
    v_exp_f32 v117, v117
    v_mfma_f32_32x32x16_bf16 v[96:111], v[200:203], v[152:155], 0
    v_exp_f32 v118, v118
    v_exp_f32 v119, v119
    v_exp_f32 v120, v120
    v_mfma_f32_32x32x16_bf16 v[96:111], v[204:207], v[156:159], v[96:111]
    v_exp_f32 v121, v121
    v_exp_f32 v122, v122
    v_exp_f32 v123, v123
    v_cvt_pk_bf16_f32 v144, v112, v113
    v_cvt_pk_bf16_f32 v145, v114, v115
    v_cvt_pk_bf16_f32 v146, v116, v117
    v_cvt_pk_bf16_f32 v147, v118, v119
    v_exp_f32 v124, v124
    v_exp_f32 v125, v125
    v_exp_f32 v126, v126
    v_exp_f32 v127, v127
    v_cvt_pk_bf16_f32 v148, v120, v121
    v_cvt_pk_bf16_f32 v149, v122, v123
    v_cvt_pk_bf16_f32 v150, v124, v125
    v_cvt_pk_bf16_f32 v151, v126, v127
    v_mfma_f32_32x32x16_bf16 v[112:127], v[208:211], v[32:35], 0
    s_waitcnt vmcnt(10)
    v_exp_f32 v128, v128
    v_exp_f32 v129, v129
    v_exp_f32 v130, v130
    v_mfma_f32_32x32x16_bf16 v[112:127], v[212:215], v[36:39], v[112:127]
    v_exp_f32 v131, v131
    v_exp_f32 v132, v132
    v_exp_f32 v133, v133
    v_mfma_f32_32x32x16_bf16 v[48:63], v[216:219], v[144:147], v[48:63]
    v_exp_f32 v134, v134
    v_exp_f32 v135, v135
    v_exp_f32 v136, v136
    v_mfma_f32_32x32x16_bf16 v[48:63], v[220:223], v[148:151], v[48:63]
    buffer_load_dwordx4 v[200:203], v8, s[72:75], 0 offen offset:2048 sc1
    buffer_load_dwordx4 v[204:207], v8, s[72:75], 0 offen offset:3072 sc1
    v_exp_f32 v137, v137
    v_exp_f32 v138, v138
    v_exp_f32 v139, v139
    v_cvt_pk_bf16_f32 v152, v128, v129
    v_cvt_pk_bf16_f32 v153, v130, v131
    v_cvt_pk_bf16_f32 v154, v132, v133
    v_cvt_pk_bf16_f32 v155, v134, v135
    v_exp_f32 v140, v140
    v_exp_f32 v141, v141
    v_exp_f32 v142, v142
    v_exp_f32 v143, v143
    v_cvt_pk_bf16_f32 v156, v136, v137
    v_cvt_pk_bf16_f32 v157, v138, v139
    v_cvt_pk_bf16_f32 v158, v140, v141
    v_cvt_pk_bf16_f32 v159, v142, v143
    v_mfma_f32_32x32x16_bf16 v[128:143], v[208:211], v[40:43], 0
    v_exp_f32 v112, v112
    v_exp_f32 v113, v113
    v_exp_f32 v114, v114
    v_mfma_f32_32x32x16_bf16 v[128:143], v[212:215], v[44:47], v[128:143]
    v_exp_f32 v115, v115
    v_exp_f32 v116, v116
    v_exp_f32 v117, v117
    v_mfma_f32_32x32x16_bf16 v[64:79], v[216:219], v[152:155], v[64:79]
    s_waitcnt vmcnt(10)
    v_exp_f32 v118, v118
    v_exp_f32 v119, v119
    v_exp_f32 v120, v120
    v_mfma_f32_32x32x16_bf16 v[64:79], v[220:223], v[156:159], v[64:79]
    v_exp_f32 v121, v121
    v_exp_f32 v122, v122
    v_exp_f32 v123, v123
    v_cvt_pk_bf16_f32 v144, v112, v113
    v_cvt_pk_bf16_f32 v145, v114, v115
    v_cvt_pk_bf16_f32 v146, v116, v117
    v_cvt_pk_bf16_f32 v147, v118, v119
    v_exp_f32 v124, v124
    v_exp_f32 v125, v125
    v_exp_f32 v126, v126
    v_exp_f32 v127, v127
    v_cvt_pk_bf16_f32 v148, v120, v121
    v_cvt_pk_bf16_f32 v149, v122, v123
    v_cvt_pk_bf16_f32 v150, v124, v125
    v_cvt_pk_bf16_f32 v151, v126, v127
    v_mfma_f32_32x32x16_bf16 v[112:127], v[224:227], v[16:19], 0
    s_add_u32 s72, s72, 4096
    v_exp_f32 v128, v128
    v_exp_f32 v129, v129
    v_exp_f32 v130, v130
    v_mfma_f32_32x32x16_bf16 v[112:127], v[228:231], v[20:23], v[112:127]
    s_addc_u32 s73, s73, 0
    v_exp_f32 v131, v131
    v_exp_f32 v132, v132
    v_exp_f32 v133, v133
    v_mfma_f32_32x32x16_bf16 v[80:95], v[216:219], v[144:147], v[80:95]
    v_exp_f32 v134, v134
    v_exp_f32 v135, v135
    v_exp_f32 v136, v136
    v_mfma_f32_32x32x16_bf16 v[80:95], v[220:223], v[148:151], v[80:95]
    buffer_load_dwordx4 v[208:211], v8, s[72:75], 0 offen offset:0 sc1
    buffer_load_dwordx4 v[212:215], v8, s[72:75], 0 offen offset:1024 sc1
    v_exp_f32 v137, v137
    v_exp_f32 v138, v138
    v_exp_f32 v139, v139
    v_cvt_pk_bf16_f32 v152, v128, v129
    v_cvt_pk_bf16_f32 v153, v130, v131
    v_cvt_pk_bf16_f32 v154, v132, v133
    v_cvt_pk_bf16_f32 v155, v134, v135
    v_exp_f32 v140, v140
    v_exp_f32 v141, v141
    v_exp_f32 v142, v142
    v_exp_f32 v143, v143
    v_cvt_pk_bf16_f32 v156, v136, v137
    v_cvt_pk_bf16_f32 v157, v138, v139
    v_cvt_pk_bf16_f32 v158, v140, v141
    v_cvt_pk_bf16_f32 v159, v142, v143
    v_mfma_f32_32x32x16_bf16 v[128:143], v[224:227], v[24:27], 0
    v_exp_f32 v112, v112
    v_exp_f32 v113, v113
    v_exp_f32 v114, v114
    v_mfma_f32_32x32x16_bf16 v[128:143], v[228:231], v[28:31], v[128:143]
    v_exp_f32 v115, v115
    v_exp_f32 v116, v116
    v_exp_f32 v117, v117
    v_mfma_f32_32x32x16_bf16 v[96:111], v[216:219], v[152:155], v[96:111]
    v_exp_f32 v118, v118
    v_exp_f32 v119, v119
    v_exp_f32 v120, v120
    v_mfma_f32_32x32x16_bf16 v[96:111], v[220:223], v[156:159], v[96:111]
    v_exp_f32 v121, v121
    v_exp_f32 v122, v122
    v_exp_f32 v123, v123
    v_cvt_pk_bf16_f32 v144, v112, v113
    v_cvt_pk_bf16_f32 v145, v114, v115
    v_cvt_pk_bf16_f32 v146, v116, v117
    v_cvt_pk_bf16_f32 v147, v118, v119
    v_exp_f32 v124, v124
    v_exp_f32 v125, v125
    v_exp_f32 v126, v126
    v_exp_f32 v127, v127
    v_cvt_pk_bf16_f32 v148, v120, v121
    v_cvt_pk_bf16_f32 v149, v122, v123
    v_cvt_pk_bf16_f32 v150, v124, v125
    v_cvt_pk_bf16_f32 v151, v126, v127
    v_mfma_f32_32x32x16_bf16 v[112:127], v[224:227], v[32:35], 0
    s_waitcnt vmcnt(10)
    v_exp_f32 v128, v128
    v_exp_f32 v129, v129
    v_exp_f32 v130, v130
    v_mfma_f32_32x32x16_bf16 v[112:127], v[228:231], v[36:39], v[112:127]
    v_exp_f32 v131, v131
    v_exp_f32 v132, v132
    v_exp_f32 v133, v133
    v_mfma_f32_32x32x16_bf16 v[48:63], v[232:235], v[144:147], v[48:63]
    v_exp_f32 v134, v134
    v_exp_f32 v135, v135
    v_exp_f32 v136, v136
    v_mfma_f32_32x32x16_bf16 v[48:63], v[236:239], v[148:151], v[48:63]
    buffer_load_dwordx4 v[216:219], v8, s[72:75], 0 offen offset:2048 sc1
    buffer_load_dwordx4 v[220:223], v8, s[72:75], 0 offen offset:3072 sc1
    v_exp_f32 v137, v137
    v_exp_f32 v138, v138
    v_exp_f32 v139, v139
    v_cvt_pk_bf16_f32 v152, v128, v129
    v_cvt_pk_bf16_f32 v153, v130, v131
    v_cvt_pk_bf16_f32 v154, v132, v133
    v_cvt_pk_bf16_f32 v155, v134, v135
    v_exp_f32 v140, v140
    v_exp_f32 v141, v141
    v_exp_f32 v142, v142
    v_exp_f32 v143, v143
    v_cvt_pk_bf16_f32 v156, v136, v137
    v_cvt_pk_bf16_f32 v157, v138, v139
    v_cvt_pk_bf16_f32 v158, v140, v141
    v_cvt_pk_bf16_f32 v159, v142, v143
    v_mfma_f32_32x32x16_bf16 v[128:143], v[224:227], v[40:43], 0
    v_exp_f32 v112, v112
    v_exp_f32 v113, v113
    v_exp_f32 v114, v114
    v_mfma_f32_32x32x16_bf16 v[128:143], v[228:231], v[44:47], v[128:143]
    v_exp_f32 v115, v115
    v_exp_f32 v116, v116
    v_exp_f32 v117, v117
    v_mfma_f32_32x32x16_bf16 v[64:79], v[232:235], v[152:155], v[64:79]
    s_waitcnt vmcnt(10)
    v_exp_f32 v118, v118
    v_exp_f32 v119, v119
    v_exp_f32 v120, v120
    v_mfma_f32_32x32x16_bf16 v[64:79], v[236:239], v[156:159], v[64:79]
    v_exp_f32 v121, v121
    v_exp_f32 v122, v122
    v_exp_f32 v123, v123
    v_cvt_pk_bf16_f32 v144, v112, v113
    v_cvt_pk_bf16_f32 v145, v114, v115
    v_cvt_pk_bf16_f32 v146, v116, v117
    v_cvt_pk_bf16_f32 v147, v118, v119
    v_exp_f32 v124, v124
    v_exp_f32 v125, v125
    v_exp_f32 v126, v126
    v_exp_f32 v127, v127
    v_cvt_pk_bf16_f32 v148, v120, v121
    v_cvt_pk_bf16_f32 v149, v122, v123
    v_cvt_pk_bf16_f32 v150, v124, v125
    v_cvt_pk_bf16_f32 v151, v126, v127
    v_mfma_f32_32x32x16_bf16 v[112:127], v[240:243], v[16:19], 0
    s_add_u32 s72, s72, 4096
    v_exp_f32 v128, v128
    v_exp_f32 v129, v129
    v_exp_f32 v130, v130
    v_mfma_f32_32x32x16_bf16 v[112:127], v[244:247], v[20:23], v[112:127]
    s_addc_u32 s73, s73, 0
    v_exp_f32 v131, v131
    v_exp_f32 v132, v132
    v_exp_f32 v133, v133
    v_mfma_f32_32x32x16_bf16 v[80:95], v[232:235], v[144:147], v[80:95]
    v_exp_f32 v134, v134
    v_exp_f32 v135, v135
    v_exp_f32 v136, v136
    v_mfma_f32_32x32x16_bf16 v[80:95], v[236:239], v[148:151], v[80:95]
    buffer_load_dwordx4 v[224:227], v8, s[72:75], 0 offen offset:0 sc1
    buffer_load_dwordx4 v[228:231], v8, s[72:75], 0 offen offset:1024 sc1
    v_exp_f32 v137, v137
    v_exp_f32 v138, v138
    v_exp_f32 v139, v139
    v_cvt_pk_bf16_f32 v152, v128, v129
    v_cvt_pk_bf16_f32 v153, v130, v131
    v_cvt_pk_bf16_f32 v154, v132, v133
    v_cvt_pk_bf16_f32 v155, v134, v135
    v_exp_f32 v140, v140
    v_exp_f32 v141, v141
    v_exp_f32 v142, v142
    v_exp_f32 v143, v143
    v_cvt_pk_bf16_f32 v156, v136, v137
    v_cvt_pk_bf16_f32 v157, v138, v139
    v_cvt_pk_bf16_f32 v158, v140, v141
    v_cvt_pk_bf16_f32 v159, v142, v143
    v_mfma_f32_32x32x16_bf16 v[128:143], v[240:243], v[24:27], 0
    v_exp_f32 v112, v112
    v_exp_f32 v113, v113
    v_exp_f32 v114, v114
    v_mfma_f32_32x32x16_bf16 v[128:143], v[244:247], v[28:31], v[128:143]
    v_exp_f32 v115, v115
    v_exp_f32 v116, v116
    v_exp_f32 v117, v117
    v_mfma_f32_32x32x16_bf16 v[96:111], v[232:235], v[152:155], v[96:111]
    v_exp_f32 v118, v118
    v_exp_f32 v119, v119
    v_exp_f32 v120, v120
    v_mfma_f32_32x32x16_bf16 v[96:111], v[236:239], v[156:159], v[96:111]
    v_exp_f32 v121, v121
    v_exp_f32 v122, v122
    v_exp_f32 v123, v123
    v_cvt_pk_bf16_f32 v144, v112, v113
    v_cvt_pk_bf16_f32 v145, v114, v115
    v_cvt_pk_bf16_f32 v146, v116, v117
    v_cvt_pk_bf16_f32 v147, v118, v119
    v_exp_f32 v124, v124
    v_exp_f32 v125, v125
    v_exp_f32 v126, v126
    v_exp_f32 v127, v127
    v_cvt_pk_bf16_f32 v148, v120, v121
    v_cvt_pk_bf16_f32 v149, v122, v123
    v_cvt_pk_bf16_f32 v150, v124, v125
    v_cvt_pk_bf16_f32 v151, v126, v127
    v_mfma_f32_32x32x16_bf16 v[112:127], v[240:243], v[32:35], 0
    s_waitcnt vmcnt(10)
    v_exp_f32 v128, v128
    v_exp_f32 v129, v129
    v_exp_f32 v130, v130
    v_mfma_f32_32x32x16_bf16 v[112:127], v[244:247], v[36:39], v[112:127]
    v_exp_f32 v131, v131
    v_exp_f32 v132, v132
    v_exp_f32 v133, v133
    v_mfma_f32_32x32x16_bf16 v[48:63], v[248:251], v[144:147], v[48:63]
    v_exp_f32 v134, v134
    v_exp_f32 v135, v135
    v_exp_f32 v136, v136
    v_mfma_f32_32x32x16_bf16 v[48:63], v[252:255], v[148:151], v[48:63]
    buffer_load_dwordx4 v[232:235], v8, s[72:75], 0 offen offset:2048 sc1
    buffer_load_dwordx4 v[236:239], v8, s[72:75], 0 offen offset:3072 sc1
    v_exp_f32 v137, v137
    v_exp_f32 v138, v138
    v_exp_f32 v139, v139
    v_cvt_pk_bf16_f32 v152, v128, v129
    v_cvt_pk_bf16_f32 v153, v130, v131
    v_cvt_pk_bf16_f32 v154, v132, v133
    v_cvt_pk_bf16_f32 v155, v134, v135
    v_exp_f32 v140, v140
    v_exp_f32 v141, v141
    v_exp_f32 v142, v142
    v_exp_f32 v143, v143
    v_cvt_pk_bf16_f32 v156, v136, v137
    v_cvt_pk_bf16_f32 v157, v138, v139
    v_cvt_pk_bf16_f32 v158, v140, v141
    v_cvt_pk_bf16_f32 v159, v142, v143
    v_mfma_f32_32x32x16_bf16 v[128:143], v[240:243], v[40:43], 0
    v_exp_f32 v112, v112
    v_exp_f32 v113, v113
    v_exp_f32 v114, v114
    v_mfma_f32_32x32x16_bf16 v[128:143], v[244:247], v[44:47], v[128:143]
    v_exp_f32 v115, v115
    v_exp_f32 v116, v116
    v_exp_f32 v117, v117
    v_mfma_f32_32x32x16_bf16 v[64:79], v[248:251], v[152:155], v[64:79]
    s_waitcnt vmcnt(10)
    v_exp_f32 v118, v118
    v_exp_f32 v119, v119
    v_exp_f32 v120, v120
    v_mfma_f32_32x32x16_bf16 v[64:79], v[252:255], v[156:159], v[64:79]
    v_exp_f32 v121, v121
    v_exp_f32 v122, v122
    v_exp_f32 v123, v123
    v_cvt_pk_bf16_f32 v144, v112, v113
    v_cvt_pk_bf16_f32 v145, v114, v115
    v_cvt_pk_bf16_f32 v146, v116, v117
    v_cvt_pk_bf16_f32 v147, v118, v119
    v_exp_f32 v124, v124
    v_exp_f32 v125, v125
    v_exp_f32 v126, v126
    v_exp_f32 v127, v127
    v_cvt_pk_bf16_f32 v148, v120, v121
    v_cvt_pk_bf16_f32 v149, v122, v123
    v_cvt_pk_bf16_f32 v150, v124, v125
    v_cvt_pk_bf16_f32 v151, v126, v127
    v_mfma_f32_32x32x16_bf16 v[112:127], v[192:195], v[16:19], 0
    s_add_u32 s72, s72, 4096
    v_exp_f32 v128, v128
    v_exp_f32 v129, v129
    v_exp_f32 v130, v130
    v_mfma_f32_32x32x16_bf16 v[112:127], v[196:199], v[20:23], v[112:127]
    s_addc_u32 s73, s73, 0
    v_exp_f32 v131, v131
    v_exp_f32 v132, v132
    v_exp_f32 v133, v133
    v_mfma_f32_32x32x16_bf16 v[80:95], v[248:251], v[144:147], v[80:95]
    v_exp_f32 v134, v134
    v_exp_f32 v135, v135
    v_exp_f32 v136, v136
    v_mfma_f32_32x32x16_bf16 v[80:95], v[252:255], v[148:151], v[80:95]
    buffer_load_dwordx4 v[240:243], v8, s[72:75], 0 offen offset:0 sc1
    buffer_load_dwordx4 v[244:247], v8, s[72:75], 0 offen offset:1024 sc1
    v_exp_f32 v137, v137
    v_exp_f32 v138, v138
    v_exp_f32 v139, v139
    v_cvt_pk_bf16_f32 v152, v128, v129
    v_cvt_pk_bf16_f32 v153, v130, v131
    v_cvt_pk_bf16_f32 v154, v132, v133
    v_cvt_pk_bf16_f32 v155, v134, v135
    v_exp_f32 v140, v140
    v_exp_f32 v141, v141
    v_exp_f32 v142, v142
    v_exp_f32 v143, v143
    v_cvt_pk_bf16_f32 v156, v136, v137
    v_cvt_pk_bf16_f32 v157, v138, v139
    v_cvt_pk_bf16_f32 v158, v140, v141
    v_cvt_pk_bf16_f32 v159, v142, v143
L_aloop:
    v_mfma_f32_32x32x16_bf16 v[128:143], v[192:195], v[24:27], 0
    v_exp_f32 v112, v112
    v_exp_f32 v113, v113
    v_exp_f32 v114, v114
    v_mfma_f32_32x32x16_bf16 v[128:143], v[196:199], v[28:31], v[128:143]
    v_exp_f32 v115, v115
    v_exp_f32 v116, v116
    v_exp_f32 v117, v117
    v_mfma_f32_32x32x16_bf16 v[96:111], v[248:251], v[152:155], v[96:111]
    v_exp_f32 v118, v118
    v_exp_f32 v119, v119
    v_exp_f32 v120, v120
    v_mfma_f32_32x32x16_bf16 v[96:111], v[252:255], v[156:159], v[96:111]
    v_exp_f32 v121, v121
    v_exp_f32 v122, v122
    v_exp_f32 v123, v123
    v_cvt_pk_bf16_f32 v144, v112, v113
    v_cvt_pk_bf16_f32 v145, v114, v115
    v_cvt_pk_bf16_f32 v146, v116, v117
    v_cvt_pk_bf16_f32 v147, v118, v119
    v_exp_f32 v124, v124
    v_exp_f32 v125, v125
    v_exp_f32 v126, v126
    v_exp_f32 v127, v127
    v_cvt_pk_bf16_f32 v148, v120, v121
    v_cvt_pk_bf16_f32 v149, v122, v123
    v_cvt_pk_bf16_f32 v150, v124, v125
    v_cvt_pk_bf16_f32 v151, v126, v127
    v_mfma_f32_32x32x16_bf16 v[112:127], v[192:195], v[32:35], 0
    s_waitcnt vmcnt(10)
    v_exp_f32 v128, v128
    v_exp_f32 v129, v129
    v_exp_f32 v130, v130
    v_mfma_f32_32x32x16_bf16 v[112:127], v[196:199], v[36:39], v[112:127]
    v_exp_f32 v131, v131
    v_exp_f32 v132, v132
    v_exp_f32 v133, v133
    v_mfma_f32_32x32x16_bf16 v[48:63], v[200:203], v[144:147], v[48:63]
    v_exp_f32 v134, v134
    v_exp_f32 v135, v135
    v_exp_f32 v136, v136
    v_mfma_f32_32x32x16_bf16 v[48:63], v[204:207], v[148:151], v[48:63]
    buffer_load_dwordx4 v[248:251], v8, s[72:75], 0 offen offset:2048 sc1
    buffer_load_dwordx4 v[252:255], v8, s[72:75], 0 offen offset:3072 sc1
    v_exp_f32 v137, v137
    v_exp_f32 v138, v138
    v_exp_f32 v139, v139
    v_cvt_pk_bf16_f32 v152, v128, v129
    v_cvt_pk_bf16_f32 v153, v130, v131
    v_cvt_pk_bf16_f32 v154, v132, v133
    v_cvt_pk_bf16_f32 v155, v134, v135
    v_exp_f32 v140, v140
    v_exp_f32 v141, v141
    v_exp_f32 v142, v142
    v_exp_f32 v143, v143
    v_cvt_pk_bf16_f32 v156, v136, v137
    v_cvt_pk_bf16_f32 v157, v138, v139
    v_cvt_pk_bf16_f32 v158, v140, v141
    v_cvt_pk_bf16_f32 v159, v142, v143
    v_mfma_f32_32x32x16_bf16 v[128:143], v[192:195], v[40:43], 0
    v_exp_f32 v112, v112
    v_exp_f32 v113, v113
    v_exp_f32 v114, v114
    v_mfma_f32_32x32x16_bf16 v[128:143], v[196:199], v[44:47], v[128:143]
    v_exp_f32 v115, v115
    v_exp_f32 v116, v116
    v_exp_f32 v117, v117
    v_mfma_f32_32x32x16_bf16 v[64:79], v[200:203], v[152:155], v[64:79]
    s_waitcnt vmcnt(10)
    v_exp_f32 v118, v118
    v_exp_f32 v119, v119
    v_exp_f32 v120, v120
    v_mfma_f32_32x32x16_bf16 v[64:79], v[204:207], v[156:159], v[64:79]
    v_exp_f32 v121, v121
    v_exp_f32 v122, v122
    v_exp_f32 v123, v123
    v_cvt_pk_bf16_f32 v144, v112, v113
    v_cvt_pk_bf16_f32 v145, v114, v115
    v_cvt_pk_bf16_f32 v146, v116, v117
    v_cvt_pk_bf16_f32 v147, v118, v119
    v_exp_f32 v124, v124
    v_exp_f32 v125, v125
    v_exp_f32 v126, v126
    v_exp_f32 v127, v127
    v_cvt_pk_bf16_f32 v148, v120, v121
    v_cvt_pk_bf16_f32 v149, v122, v123
    v_cvt_pk_bf16_f32 v150, v124, v125
    v_cvt_pk_bf16_f32 v151, v126, v127
    v_mfma_f32_32x32x16_bf16 v[112:127], v[208:211], v[16:19], 0
    s_add_u32 s72, s72, 4096
    v_exp_f32 v128, v128
    v_exp_f32 v129, v129
    v_exp_f32 v130, v130
    v_mfma_f32_32x32x16_bf16 v[112:127], v[212:215], v[20:23], v[112:127]
    s_addc_u32 s73, s73, 0
    v_exp_f32 v131, v131
    v_exp_f32 v132, v132
    v_exp_f32 v133, v133
    v_mfma_f32_32x32x16_bf16 v[80:95], v[200:203], v[144:147], v[80:95]
    v_exp_f32 v134, v134
    v_exp_f32 v135, v135
    v_exp_f32 v136, v136
    v_mfma_f32_32x32x16_bf16 v[80:95], v[204:207], v[148:151], v[80:95]
    buffer_load_dwordx4 v[192:195], v8, s[72:75], 0 offen offset:0 sc1
    buffer_load_dwordx4 v[196:199], v8, s[72:75], 0 offen offset:1024 sc1
    v_exp_f32 v137, v137
    v_exp_f32 v138, v138
    v_exp_f32 v139, v139
    v_cvt_pk_bf16_f32 v152, v128, v129
    v_cvt_pk_bf16_f32 v153, v130, v131
    v_cvt_pk_bf16_f32 v154, v132, v133
    v_cvt_pk_bf16_f32 v155, v134, v135
    v_exp_f32 v140, v140
    v_exp_f32 v141, v141
    v_exp_f32 v142, v142
    v_exp_f32 v143, v143
    v_cvt_pk_bf16_f32 v156, v136, v137
    v_cvt_pk_bf16_f32 v157, v138, v139
    v_cvt_pk_bf16_f32 v158, v140, v141
    v_cvt_pk_bf16_f32 v159, v142, v143
    v_mfma_f32_32x32x16_bf16 v[128:143], v[208:211], v[24:27], 0
    v_exp_f32 v112, v112
    v_exp_f32 v113, v113
    v_exp_f32 v114, v114
    v_mfma_f32_32x32x16_bf16 v[128:143], v[212:215], v[28:31], v[128:143]
    v_exp_f32 v115, v115
    v_exp_f32 v116, v116
    v_exp_f32 v117, v117
    v_mfma_f32_32x32x16_bf16 v[96:111], v[200:203], v[152:155], v[96:111]
    v_exp_f32 v118, v118
    v_exp_f32 v119, v119
    v_exp_f32 v120, v120
    v_mfma_f32_32x32x16_bf16 v[96:111], v[204:207], v[156:159], v[96:111]
    v_exp_f32 v121, v121
    v_exp_f32 v122, v122
    v_exp_f32 v123, v123
    v_cvt_pk_bf16_f32 v144, v112, v113
    v_cvt_pk_bf16_f32 v145, v114, v115
    v_cvt_pk_bf16_f32 v146, v116, v117
    v_cvt_pk_bf16_f32 v147, v118, v119
    v_exp_f32 v124, v124
    v_exp_f32 v125, v125
    v_exp_f32 v126, v126
    v_exp_f32 v127, v127
    v_cvt_pk_bf16_f32 v148, v120, v121
    v_cvt_pk_bf16_f32 v149, v122, v123
    v_cvt_pk_bf16_f32 v150, v124, v125
    v_cvt_pk_bf16_f32 v151, v126, v127
    v_mfma_f32_32x32x16_bf16 v[112:127], v[208:211], v[32:35], 0
    s_waitcnt vmcnt(10)
    v_exp_f32 v128, v128
    v_exp_f32 v129, v129
    v_exp_f32 v130, v130
    v_mfma_f32_32x32x16_bf16 v[112:127], v[212:215], v[36:39], v[112:127]
    v_exp_f32 v131, v131
    v_exp_f32 v132, v132
    v_exp_f32 v133, v133
    v_mfma_f32_32x32x16_bf16 v[48:63], v[216:219], v[144:147], v[48:63]
    v_exp_f32 v134, v134
    v_exp_f32 v135, v135
    v_exp_f32 v136, v136
    v_mfma_f32_32x32x16_bf16 v[48:63], v[220:223], v[148:151], v[48:63]
    buffer_load_dwordx4 v[200:203], v8, s[72:75], 0 offen offset:2048 sc1
    buffer_load_dwordx4 v[204:207], v8, s[72:75], 0 offen offset:3072 sc1
    v_exp_f32 v137, v137
    v_exp_f32 v138, v138
    v_exp_f32 v139, v139
    v_cvt_pk_bf16_f32 v152, v128, v129
    v_cvt_pk_bf16_f32 v153, v130, v131
    v_cvt_pk_bf16_f32 v154, v132, v133
    v_cvt_pk_bf16_f32 v155, v134, v135
    v_exp_f32 v140, v140
    v_exp_f32 v141, v141
    v_exp_f32 v142, v142
    v_exp_f32 v143, v143
    v_cvt_pk_bf16_f32 v156, v136, v137
    v_cvt_pk_bf16_f32 v157, v138, v139
    v_cvt_pk_bf16_f32 v158, v140, v141
    v_cvt_pk_bf16_f32 v159, v142, v143
    v_mfma_f32_32x32x16_bf16 v[128:143], v[208:211], v[40:43], 0
    v_exp_f32 v112, v112
    v_exp_f32 v113, v113
    v_exp_f32 v114, v114
    v_mfma_f32_32x32x16_bf16 v[128:143], v[212:215], v[44:47], v[128:143]
    v_exp_f32 v115, v115
    v_exp_f32 v116, v116
    v_exp_f32 v117, v117
    v_mfma_f32_32x32x16_bf16 v[64:79], v[216:219], v[152:155], v[64:79]
    s_waitcnt vmcnt(10)
    v_exp_f32 v118, v118
    v_exp_f32 v119, v119
    v_exp_f32 v120, v120
    v_mfma_f32_32x32x16_bf16 v[64:79], v[220:223], v[156:159], v[64:79]
    v_exp_f32 v121, v121
    v_exp_f32 v122, v122
    v_exp_f32 v123, v123
    v_cvt_pk_bf16_f32 v144, v112, v113
    v_cvt_pk_bf16_f32 v145, v114, v115
    v_cvt_pk_bf16_f32 v146, v116, v117
    v_cvt_pk_bf16_f32 v147, v118, v119
    v_exp_f32 v124, v124
    v_exp_f32 v125, v125
    v_exp_f32 v126, v126
    v_exp_f32 v127, v127
    v_cvt_pk_bf16_f32 v148, v120, v121
    v_cvt_pk_bf16_f32 v149, v122, v123
    v_cvt_pk_bf16_f32 v150, v124, v125
    v_cvt_pk_bf16_f32 v151, v126, v127
    v_mfma_f32_32x32x16_bf16 v[112:127], v[224:227], v[16:19], 0
    s_add_u32 s72, s72, 4096
    v_exp_f32 v128, v128
    v_exp_f32 v129, v129
    v_exp_f32 v130, v130
    v_mfma_f32_32x32x16_bf16 v[112:127], v[228:231], v[20:23], v[112:127]
    s_addc_u32 s73, s73, 0
    v_exp_f32 v131, v131
    v_exp_f32 v132, v132
    v_exp_f32 v133, v133
    v_mfma_f32_32x32x16_bf16 v[80:95], v[216:219], v[144:147], v[80:95]
    v_exp_f32 v134, v134
    v_exp_f32 v135, v135
    v_exp_f32 v136, v136
    v_mfma_f32_32x32x16_bf16 v[80:95], v[220:223], v[148:151], v[80:95]
    buffer_load_dwordx4 v[208:211], v8, s[72:75], 0 offen offset:0 sc1
    buffer_load_dwordx4 v[212:215], v8, s[72:75], 0 offen offset:1024 sc1
    v_exp_f32 v137, v137
    v_exp_f32 v138, v138
    v_exp_f32 v139, v139
    v_cvt_pk_bf16_f32 v152, v128, v129
    v_cvt_pk_bf16_f32 v153, v130, v131
    v_cvt_pk_bf16_f32 v154, v132, v133
    v_cvt_pk_bf16_f32 v155, v134, v135
    v_exp_f32 v140, v140
    v_exp_f32 v141, v141
    v_exp_f32 v142, v142
    v_exp_f32 v143, v143
    v_cvt_pk_bf16_f32 v156, v136, v137
    v_cvt_pk_bf16_f32 v157, v138, v139
    v_cvt_pk_bf16_f32 v158, v140, v141
    v_cvt_pk_bf16_f32 v159, v142, v143
    v_mfma_f32_32x32x16_bf16 v[128:143], v[224:227], v[24:27], 0
    v_exp_f32 v112, v112
    v_exp_f32 v113, v113
    v_exp_f32 v114, v114
    v_mfma_f32_32x32x16_bf16 v[128:143], v[228:231], v[28:31], v[128:143]
    v_exp_f32 v115, v115
    v_exp_f32 v116, v116
    v_exp_f32 v117, v117
    v_mfma_f32_32x32x16_bf16 v[96:111], v[216:219], v[152:155], v[96:111]
    v_exp_f32 v118, v118
    v_exp_f32 v119, v119
    v_exp_f32 v120, v120
    v_mfma_f32_32x32x16_bf16 v[96:111], v[220:223], v[156:159], v[96:111]
    v_exp_f32 v121, v121
    v_exp_f32 v122, v122
    v_exp_f32 v123, v123
    v_cvt_pk_bf16_f32 v144, v112, v113
    v_cvt_pk_bf16_f32 v145, v114, v115
    v_cvt_pk_bf16_f32 v146, v116, v117
    v_cvt_pk_bf16_f32 v147, v118, v119
    v_exp_f32 v124, v124
    v_exp_f32 v125, v125
    v_exp_f32 v126, v126
    v_exp_f32 v127, v127
    v_cvt_pk_bf16_f32 v148, v120, v121
    v_cvt_pk_bf16_f32 v149, v122, v123
    v_cvt_pk_bf16_f32 v150, v124, v125
    v_cvt_pk_bf16_f32 v151, v126, v127
    v_mfma_f32_32x32x16_bf16 v[112:127], v[224:227], v[32:35], 0
    s_waitcnt vmcnt(10)
    v_exp_f32 v128, v128
    v_exp_f32 v129, v129
    v_exp_f32 v130, v130
    v_mfma_f32_32x32x16_bf16 v[112:127], v[228:231], v[36:39], v[112:127]
    v_exp_f32 v131, v131
    v_exp_f32 v132, v132
    v_exp_f32 v133, v133
    v_mfma_f32_32x32x16_bf16 v[48:63], v[232:235], v[144:147], v[48:63]
    v_exp_f32 v134, v134
    v_exp_f32 v135, v135
    v_exp_f32 v136, v136
    v_mfma_f32_32x32x16_bf16 v[48:63], v[236:239], v[148:151], v[48:63]
    buffer_load_dwordx4 v[216:219], v8, s[72:75], 0 offen offset:2048 sc1
    buffer_load_dwordx4 v[220:223], v8, s[72:75], 0 offen offset:3072 sc1
    v_exp_f32 v137, v137
    v_exp_f32 v138, v138
    v_exp_f32 v139, v139
    v_cvt_pk_bf16_f32 v152, v128, v129
    v_cvt_pk_bf16_f32 v153, v130, v131
    v_cvt_pk_bf16_f32 v154, v132, v133
    v_cvt_pk_bf16_f32 v155, v134, v135
    v_exp_f32 v140, v140
    v_exp_f32 v141, v141
    v_exp_f32 v142, v142
    v_exp_f32 v143, v143
    v_cvt_pk_bf16_f32 v156, v136, v137
    v_cvt_pk_bf16_f32 v157, v138, v139
    v_cvt_pk_bf16_f32 v158, v140, v141
    v_cvt_pk_bf16_f32 v159, v142, v143
    v_mfma_f32_32x32x16_bf16 v[128:143], v[224:227], v[40:43], 0
    v_exp_f32 v112, v112
    v_exp_f32 v113, v113
    v_exp_f32 v114, v114
    v_mfma_f32_32x32x16_bf16 v[128:143], v[228:231], v[44:47], v[128:143]
    v_exp_f32 v115, v115
    v_exp_f32 v116, v116
    v_exp_f32 v117, v117
    v_mfma_f32_32x32x16_bf16 v[64:79], v[232:235], v[152:155], v[64:79]
    s_waitcnt vmcnt(10)
    v_exp_f32 v118, v118
    v_exp_f32 v119, v119
    v_exp_f32 v120, v120
    v_mfma_f32_32x32x16_bf16 v[64:79], v[236:239], v[156:159], v[64:79]
    v_exp_f32 v121, v121
    v_exp_f32 v122, v122
    v_exp_f32 v123, v123
    v_cvt_pk_bf16_f32 v144, v112, v113
    v_cvt_pk_bf16_f32 v145, v114, v115
    v_cvt_pk_bf16_f32 v146, v116, v117
    v_cvt_pk_bf16_f32 v147, v118, v119
    v_exp_f32 v124, v124
    v_exp_f32 v125, v125
    v_exp_f32 v126, v126
    v_exp_f32 v127, v127
    v_cvt_pk_bf16_f32 v148, v120, v121
    v_cvt_pk_bf16_f32 v149, v122, v123
    v_cvt_pk_bf16_f32 v150, v124, v125
    v_cvt_pk_bf16_f32 v151, v126, v127
    v_mfma_f32_32x32x16_bf16 v[112:127], v[240:243], v[16:19], 0
    s_add_u32 s72, s72, 4096
    v_exp_f32 v128, v128
    v_exp_f32 v129, v129
    v_exp_f32 v130, v130
    v_mfma_f32_32x32x16_bf16 v[112:127], v[244:247], v[20:23], v[112:127]
    s_addc_u32 s73, s73, 0
    v_exp_f32 v131, v131
    v_exp_f32 v132, v132
    v_exp_f32 v133, v133
    v_mfma_f32_32x32x16_bf16 v[80:95], v[232:235], v[144:147], v[80:95]
    v_exp_f32 v134, v134
    v_exp_f32 v135, v135
    v_exp_f32 v136, v136
    v_mfma_f32_32x32x16_bf16 v[80:95], v[236:239], v[148:151], v[80:95]
    buffer_load_dwordx4 v[224:227], v8, s[72:75], 0 offen offset:0 sc1
    buffer_load_dwordx4 v[228:231], v8, s[72:75], 0 offen offset:1024 sc1
    v_exp_f32 v137, v137
    v_exp_f32 v138, v138
    v_exp_f32 v139, v139
    v_cvt_pk_bf16_f32 v152, v128, v129
    v_cvt_pk_bf16_f32 v153, v130, v131
    v_cvt_pk_bf16_f32 v154, v132, v133
    v_cvt_pk_bf16_f32 v155, v134, v135
    v_exp_f32 v140, v140
    v_exp_f32 v141, v141
    v_exp_f32 v142, v142
    v_exp_f32 v143, v143
    v_cvt_pk_bf16_f32 v156, v136, v137
    v_cvt_pk_bf16_f32 v157, v138, v139
    v_cvt_pk_bf16_f32 v158, v140, v141
    v_cvt_pk_bf16_f32 v159, v142, v143
    v_mfma_f32_32x32x16_bf16 v[128:143], v[240:243], v[24:27], 0
    v_exp_f32 v112, v112
    v_exp_f32 v113, v113
    v_exp_f32 v114, v114
    v_mfma_f32_32x32x16_bf16 v[128:143], v[244:247], v[28:31], v[128:143]
    v_exp_f32 v115, v115
    v_exp_f32 v116, v116
    v_exp_f32 v117, v117
    v_mfma_f32_32x32x16_bf16 v[96:111], v[232:235], v[152:155], v[96:111]
    v_exp_f32 v118, v118
    v_exp_f32 v119, v119
    v_exp_f32 v120, v120
    v_mfma_f32_32x32x16_bf16 v[96:111], v[236:239], v[156:159], v[96:111]
    v_exp_f32 v121, v121
    v_exp_f32 v122, v122
    v_exp_f32 v123, v123
    v_cvt_pk_bf16_f32 v144, v112, v113
    v_cvt_pk_bf16_f32 v145, v114, v115
    v_cvt_pk_bf16_f32 v146, v116, v117
    v_cvt_pk_bf16_f32 v147, v118, v119
    v_exp_f32 v124, v124
    v_exp_f32 v125, v125
    v_exp_f32 v126, v126
    v_exp_f32 v127, v127
    v_cvt_pk_bf16_f32 v148, v120, v121
    v_cvt_pk_bf16_f32 v149, v122, v123
    v_cvt_pk_bf16_f32 v150, v124, v125
    v_cvt_pk_bf16_f32 v151, v126, v127
    v_mfma_f32_32x32x16_bf16 v[112:127], v[240:243], v[32:35], 0
    s_waitcnt vmcnt(10)
    v_exp_f32 v128, v128
    v_exp_f32 v129, v129
    v_exp_f32 v130, v130
    v_mfma_f32_32x32x16_bf16 v[112:127], v[244:247], v[36:39], v[112:127]
    v_exp_f32 v131, v131
    v_exp_f32 v132, v132
    v_exp_f32 v133, v133
    v_mfma_f32_32x32x16_bf16 v[48:63], v[248:251], v[144:147], v[48:63]
    v_exp_f32 v134, v134
    v_exp_f32 v135, v135
    v_exp_f32 v136, v136
    v_mfma_f32_32x32x16_bf16 v[48:63], v[252:255], v[148:151], v[48:63]
    buffer_load_dwordx4 v[232:235], v8, s[72:75], 0 offen offset:2048 sc1
    buffer_load_dwordx4 v[236:239], v8, s[72:75], 0 offen offset:3072 sc1
    v_exp_f32 v137, v137
    v_exp_f32 v138, v138
    v_exp_f32 v139, v139
    v_cvt_pk_bf16_f32 v152, v128, v129
    v_cvt_pk_bf16_f32 v153, v130, v131
    v_cvt_pk_bf16_f32 v154, v132, v133
    v_cvt_pk_bf16_f32 v155, v134, v135
    v_exp_f32 v140, v140
    v_exp_f32 v141, v141
    v_exp_f32 v142, v142
    v_exp_f32 v143, v143
    v_cvt_pk_bf16_f32 v156, v136, v137
    v_cvt_pk_bf16_f32 v157, v138, v139
    v_cvt_pk_bf16_f32 v158, v140, v141
    v_cvt_pk_bf16_f32 v159, v142, v143
    v_mfma_f32_32x32x16_bf16 v[128:143], v[240:243], v[40:43], 0
    v_exp_f32 v112, v112
    v_exp_f32 v113, v113
    v_exp_f32 v114, v114
    v_mfma_f32_32x32x16_bf16 v[128:143], v[244:247], v[44:47], v[128:143]
    v_exp_f32 v115, v115
    v_exp_f32 v116, v116
    v_exp_f32 v117, v117
    v_mfma_f32_32x32x16_bf16 v[64:79], v[248:251], v[152:155], v[64:79]
    s_waitcnt vmcnt(10)
    v_exp_f32 v118, v118
    v_exp_f32 v119, v119
    v_exp_f32 v120, v120
    v_mfma_f32_32x32x16_bf16 v[64:79], v[252:255], v[156:159], v[64:79]
    v_exp_f32 v121, v121
    v_exp_f32 v122, v122
    v_exp_f32 v123, v123
    v_cvt_pk_bf16_f32 v144, v112, v113
    v_cvt_pk_bf16_f32 v145, v114, v115
    v_cvt_pk_bf16_f32 v146, v116, v117
    v_cvt_pk_bf16_f32 v147, v118, v119
    v_exp_f32 v124, v124
    v_exp_f32 v125, v125
    v_exp_f32 v126, v126
    v_exp_f32 v127, v127
    v_cvt_pk_bf16_f32 v148, v120, v121
    v_cvt_pk_bf16_f32 v149, v122, v123
    v_cvt_pk_bf16_f32 v150, v124, v125
    v_cvt_pk_bf16_f32 v151, v126, v127
    v_mfma_f32_32x32x16_bf16 v[112:127], v[192:195], v[16:19], 0
    s_add_u32 s72, s72, 4096
    v_exp_f32 v128, v128
    v_exp_f32 v129, v129
    v_exp_f32 v130, v130
    v_mfma_f32_32x32x16_bf16 v[112:127], v[196:199], v[20:23], v[112:127]
    s_addc_u32 s73, s73, 0
    v_exp_f32 v131, v131
    v_exp_f32 v132, v132
    v_exp_f32 v133, v133
    v_mfma_f32_32x32x16_bf16 v[80:95], v[248:251], v[144:147], v[80:95]
    v_exp_f32 v134, v134
    v_exp_f32 v135, v135
    v_exp_f32 v136, v136
    v_mfma_f32_32x32x16_bf16 v[80:95], v[252:255], v[148:151], v[80:95]
    buffer_load_dwordx4 v[240:243], v8, s[72:75], 0 offen offset:0 sc1
    buffer_load_dwordx4 v[244:247], v8, s[72:75], 0 offen offset:1024 sc1
    v_exp_f32 v137, v137
    v_exp_f32 v138, v138
    s_sub_u32 s78, s78, 1
    v_exp_f32 v139, v139
    v_cvt_pk_bf16_f32 v152, v128, v129
    v_cvt_pk_bf16_f32 v153, v130, v131
    v_cvt_pk_bf16_f32 v154, v132, v133
    v_cvt_pk_bf16_f32 v155, v134, v135
    v_exp_f32 v140, v140
    v_exp_f32 v141, v141
    v_exp_f32 v142, v142
    v_exp_f32 v143, v143
    v_cvt_pk_bf16_f32 v156, v136, v137
    v_cvt_pk_bf16_f32 v157, v138, v139
    v_cvt_pk_bf16_f32 v158, v140, v141
    v_cvt_pk_bf16_f32 v159, v142, v143
    s_cbranch_scc0 L_aloop
    v_mfma_f32_32x32x16_bf16 v[128:143], v[192:195], v[24:27], 0
    v_exp_f32 v112, v112
    v_exp_f32 v113, v113
    v_exp_f32 v114, v114
    v_mfma_f32_32x32x16_bf16 v[128:143], v[196:199], v[28:31], v[128:143]
    v_exp_f32 v115, v115
    v_exp_f32 v116, v116
    v_exp_f32 v117, v117
    v_mfma_f32_32x32x16_bf16 v[96:111], v[248:251], v[152:155], v[96:111]
    s_waitcnt vmcnt(8)
    v_exp_f32 v118, v118
    v_exp_f32 v119, v119
    v_exp_f32 v120, v120
    v_mfma_f32_32x32x16_bf16 v[96:111], v[252:255], v[156:159], v[96:111]
    buffer_load_dwordx4 v[248:251], v8, s[72:75], 0 offen offset:2048 sc1
    buffer_load_dwordx4 v[252:255], v8, s[72:75], 0 offen offset:3072 sc1
    v_exp_f32 v121, v121
    v_exp_f32 v122, v122
    v_exp_f32 v123, v123
    v_cvt_pk_bf16_f32 v144, v112, v113
    v_cvt_pk_bf16_f32 v145, v114, v115
    v_cvt_pk_bf16_f32 v146, v116, v117
    v_cvt_pk_bf16_f32 v147, v118, v119
    v_exp_f32 v124, v124
    v_exp_f32 v125, v125
    v_exp_f32 v126, v126
    v_exp_f32 v127, v127
    v_cvt_pk_bf16_f32 v148, v120, v121
    v_cvt_pk_bf16_f32 v149, v122, v123
    v_cvt_pk_bf16_f32 v150, v124, v125
    v_cvt_pk_bf16_f32 v151, v126, v127
    v_mfma_f32_32x32x16_bf16 v[112:127], v[208:211], v[16:19], 0
    v_exp_f32 v128, v128
    v_exp_f32 v129, v129
    v_exp_f32 v130, v130
    v_mfma_f32_32x32x16_bf16 v[112:127], v[212:215], v[20:23], v[112:127]
    v_exp_f32 v131, v131
    v_exp_f32 v132, v132
    v_exp_f32 v133, v133
    v_mfma_f32_32x32x16_bf16 v[48:63], v[200:203], v[144:147], v[48:63]
    v_exp_f32 v134, v134
    v_exp_f32 v135, v135
    v_exp_f32 v136, v136
    v_mfma_f32_32x32x16_bf16 v[48:63], v[204:207], v[148:151], v[48:63]
    v_exp_f32 v137, v137
    v_exp_f32 v138, v138
    v_exp_f32 v139, v139
    v_cvt_pk_bf16_f32 v152, v128, v129
    v_cvt_pk_bf16_f32 v153, v130, v131
    v_cvt_pk_bf16_f32 v154, v132, v133
    v_cvt_pk_bf16_f32 v155, v134, v135
    v_exp_f32 v140, v140
    v_exp_f32 v141, v141
    v_exp_f32 v142, v142
    v_exp_f32 v143, v143
    v_cvt_pk_bf16_f32 v156, v136, v137
    v_cvt_pk_bf16_f32 v157, v138, v139
    v_cvt_pk_bf16_f32 v158, v140, v141
    v_cvt_pk_bf16_f32 v159, v142, v143
    v_mfma_f32_32x32x16_bf16 v[128:143], v[208:211], v[24:27], 0
    v_exp_f32 v112, v112
    v_exp_f32 v113, v113
    v_exp_f32 v114, v114
    v_mfma_f32_32x32x16_bf16 v[128:143], v[212:215], v[28:31], v[128:143]
    v_exp_f32 v115, v115
    v_exp_f32 v116, v116
    v_exp_f32 v117, v117
    v_mfma_f32_32x32x16_bf16 v[64:79], v[200:203], v[152:155], v[64:79]
    s_waitcnt vmcnt(6)
    v_exp_f32 v118, v118
    v_exp_f32 v119, v119
    v_exp_f32 v120, v120
    v_mfma_f32_32x32x16_bf16 v[64:79], v[204:207], v[156:159], v[64:79]
    v_exp_f32 v121, v121
    v_exp_f32 v122, v122
    v_exp_f32 v123, v123
    v_cvt_pk_bf16_f32 v144, v112, v113
    v_cvt_pk_bf16_f32 v145, v114, v115
    v_cvt_pk_bf16_f32 v146, v116, v117
    v_cvt_pk_bf16_f32 v147, v118, v119
    v_exp_f32 v124, v124
    v_exp_f32 v125, v125
    v_exp_f32 v126, v126
    v_exp_f32 v127, v127
    v_cvt_pk_bf16_f32 v148, v120, v121
    v_cvt_pk_bf16_f32 v149, v122, v123
    v_cvt_pk_bf16_f32 v150, v124, v125
    v_cvt_pk_bf16_f32 v151, v126, v127
    v_mfma_f32_32x32x16_bf16 v[112:127], v[224:227], v[16:19], 0
    v_exp_f32 v128, v128
    v_exp_f32 v129, v129
    v_exp_f32 v130, v130
    v_mfma_f32_32x32x16_bf16 v[112:127], v[228:231], v[20:23], v[112:127]
    v_exp_f32 v131, v131
    v_exp_f32 v132, v132
    v_exp_f32 v133, v133
    v_mfma_f32_32x32x16_bf16 v[48:63], v[216:219], v[144:147], v[48:63]
    v_exp_f32 v134, v134
    v_exp_f32 v135, v135
    v_exp_f32 v136, v136
    v_mfma_f32_32x32x16_bf16 v[48:63], v[220:223], v[148:151], v[48:63]
    v_exp_f32 v137, v137
    v_exp_f32 v138, v138
    v_exp_f32 v139, v139
    v_cvt_pk_bf16_f32 v152, v128, v129
    v_cvt_pk_bf16_f32 v153, v130, v131
    v_cvt_pk_bf16_f32 v154, v132, v133
    v_cvt_pk_bf16_f32 v155, v134, v135
    v_exp_f32 v140, v140
    v_exp_f32 v141, v141
    v_exp_f32 v142, v142
    v_exp_f32 v143, v143
    v_cvt_pk_bf16_f32 v156, v136, v137
    v_cvt_pk_bf16_f32 v157, v138, v139
    v_cvt_pk_bf16_f32 v158, v140, v141
    v_cvt_pk_bf16_f32 v159, v142, v143
    v_mfma_f32_32x32x16_bf16 v[128:143], v[224:227], v[24:27], 0
    v_exp_f32 v112, v112
    v_exp_f32 v113, v113
    v_exp_f32 v114, v114
    v_mfma_f32_32x32x16_bf16 v[128:143], v[228:231], v[28:31], v[128:143]
    v_exp_f32 v115, v115
    v_exp_f32 v116, v116
    v_exp_f32 v117, v117
    v_mfma_f32_32x32x16_bf16 v[64:79], v[216:219], v[152:155], v[64:79]
    s_waitcnt vmcnt(2)
    v_exp_f32 v118, v118
    v_exp_f32 v119, v119
    v_exp_f32 v120, v120
    v_mfma_f32_32x32x16_bf16 v[64:79], v[220:223], v[156:159], v[64:79]
    v_exp_f32 v121, v121
    v_exp_f32 v122, v122
    v_exp_f32 v123, v123
    v_cvt_pk_bf16_f32 v144, v112, v113
    v_cvt_pk_bf16_f32 v145, v114, v115
    v_cvt_pk_bf16_f32 v146, v116, v117
    v_cvt_pk_bf16_f32 v147, v118, v119
    v_exp_f32 v124, v124
    v_exp_f32 v125, v125
    v_exp_f32 v126, v126
    v_exp_f32 v127, v127
    v_cvt_pk_bf16_f32 v148, v120, v121
    v_cvt_pk_bf16_f32 v149, v122, v123
    v_cvt_pk_bf16_f32 v150, v124, v125
    v_cvt_pk_bf16_f32 v151, v126, v127
    v_mfma_f32_32x32x16_bf16 v[112:127], v[240:243], v[16:19], 0
    ds_read_b32 v176, v173 offset:16
    v_exp_f32 v128, v128
    v_exp_f32 v129, v129
    v_exp_f32 v130, v130
    v_mfma_f32_32x32x16_bf16 v[112:127], v[244:247], v[20:23], v[112:127]
    v_exp_f32 v131, v131
    v_exp_f32 v132, v132
    v_exp_f32 v133, v133
    v_mfma_f32_32x32x16_bf16 v[48:63], v[232:235], v[144:147], v[48:63]
    v_exp_f32 v134, v134
    v_exp_f32 v135, v135
    v_exp_f32 v136, v136
    v_mfma_f32_32x32x16_bf16 v[48:63], v[236:239], v[148:151], v[48:63]
    s_waitcnt lgkmcnt(0)
    v_exp_f32 v137, v137
    v_exp_f32 v138, v138
    v_exp_f32 v139, v139
    v_cvt_pk_bf16_f32 v152, v128, v129
    v_cvt_pk_bf16_f32 v153, v130, v131
    v_cvt_pk_bf16_f32 v154, v132, v133
    v_cvt_pk_bf16_f32 v155, v134, v135
    v_exp_f32 v140, v140
    v_cmp_gt_u32 vcc, s90, v176
    v_exp_f32 v141, v141
    v_exp_f32 v142, v142
    s_cbranch_vccnz L_f1
L_f1_ok:
    v_exp_f32 v143, v143
    v_cvt_pk_bf16_f32 v156, v136, v137
    v_cvt_pk_bf16_f32 v157, v138, v139
    v_cvt_pk_bf16_f32 v158, v140, v141
    v_cvt_pk_bf16_f32 v159, v142, v143
    v_mfma_f32_32x32x16_bf16 v[128:143], v[240:243], v[24:27], 0
    v_exp_f32 v112, v112
    v_exp_f32 v113, v113
    v_exp_f32 v114, v114
    v_mfma_f32_32x32x16_bf16 v[128:143], v[244:247], v[28:31], v[128:143]
    v_exp_f32 v115, v115
    v_exp_f32 v116, v116
    v_exp_f32 v117, v117
    v_mfma_f32_32x32x16_bf16 v[64:79], v[232:235], v[152:155], v[64:79]
    v_exp_f32 v118, v118
    v_exp_f32 v119, v119
    v_exp_f32 v120, v120
    v_mfma_f32_32x32x16_bf16 v[64:79], v[236:239], v[156:159], v[64:79]
    v_exp_f32 v121, v121
    v_exp_f32 v122, v122
    v_exp_f32 v123, v123
    v_cvt_pk_bf16_f32 v144, v112, v113
    v_cvt_pk_bf16_f32 v145, v114, v115
    v_cvt_pk_bf16_f32 v146, v116, v117
    v_cvt_pk_bf16_f32 v147, v118, v119
    v_exp_f32 v124, v124
    v_exp_f32 v125, v125
    v_exp_f32 v126, v126
    v_exp_f32 v127, v127
    v_cvt_pk_bf16_f32 v148, v120, v121
    v_cvt_pk_bf16_f32 v149, v122, v123
    v_cvt_pk_bf16_f32 v150, v124, v125
    v_cvt_pk_bf16_f32 v151, v126, v127
    v_mfma_f32_32x32x16_bf16 v[112:127], v[192:195], v[32:35], 0
    s_waitcnt vmcnt(0)
    v_exp_f32 v128, v128
    v_exp_f32 v129, v129
    v_exp_f32 v130, v130
    v_mfma_f32_32x32x16_bf16 v[112:127], v[196:199], v[36:39], v[112:127]
    v_exp_f32 v131, v131
    v_exp_f32 v132, v132
    v_exp_f32 v133, v133
    v_mfma_f32_32x32x16_bf16 v[48:63], v[248:251], v[144:147], v[48:63]
    v_exp_f32 v134, v134
    v_exp_f32 v135, v135
    v_exp_f32 v136, v136
    v_mfma_f32_32x32x16_bf16 v[48:63], v[252:255], v[148:151], v[48:63]
    v_exp_f32 v137, v137
    v_exp_f32 v138, v138
    v_exp_f32 v139, v139
    v_cvt_pk_bf16_f32 v152, v128, v129
    v_cvt_pk_bf16_f32 v153, v130, v131
    v_cvt_pk_bf16_f32 v154, v132, v133
    v_cvt_pk_bf16_f32 v155, v134, v135
    v_exp_f32 v140, v140
    v_exp_f32 v141, v141
    v_exp_f32 v142, v142
    v_exp_f32 v143, v143
    v_cvt_pk_bf16_f32 v156, v136, v137
    v_cvt_pk_bf16_f32 v157, v138, v139
    v_cvt_pk_bf16_f32 v158, v140, v141
    v_cvt_pk_bf16_f32 v159, v142, v143
    v_mfma_f32_32x32x16_bf16 v[128:143], v[208:211], v[32:35], 0
    ds_write_b128 v168, v[48:51] offset:0
    v_exp_f32 v112, v112
    v_exp_f32 v113, v113
    v_exp_f32 v114, v114
    v_mfma_f32_32x32x16_bf16 v[128:143], v[212:215], v[36:39], v[128:143]
    ds_write_b128 v168, v[52:55] offset:1024
    v_exp_f32 v115, v115
    v_exp_f32 v116, v116
    v_exp_f32 v117, v117
    v_mfma_f32_32x32x16_bf16 v[64:79], v[248:251], v[152:155], v[64:79]
    ds_write_b128 v168, v[56:59] offset:2048
    v_exp_f32 v118, v118
    v_exp_f32 v119, v119
    v_exp_f32 v120, v120
    v_mfma_f32_32x32x16_bf16 v[64:79], v[252:255], v[156:159], v[64:79]
    ds_write_b128 v168, v[60:63] offset:3072
    v_exp_f32 v121, v121
    v_exp_f32 v122, v122
    v_exp_f32 v123, v123
    v_cvt_pk_bf16_f32 v144, v112, v113
    v_cvt_pk_bf16_f32 v145, v114, v115
    v_cvt_pk_bf16_f32 v146, v116, v117
    v_cvt_pk_bf16_f32 v147, v118, v119
    v_exp_f32 v124, v124
    v_exp_f32 v125, v125
    v_exp_f32 v126, v126
    v_exp_f32 v127, v127
    v_cvt_pk_bf16_f32 v148, v120, v121
    v_cvt_pk_bf16_f32 v149, v122, v123
    v_cvt_pk_bf16_f32 v150, v124, v125
    v_cvt_pk_bf16_f32 v151, v126, v127
    v_mfma_f32_32x32x16_bf16 v[112:127], v[224:227], v[32:35], 0
    ds_write_b128 v169, v[64:67] offset:4096
    v_exp_f32 v128, v128
    v_exp_f32 v129, v129
    v_exp_f32 v130, v130
    v_mfma_f32_32x32x16_bf16 v[112:127], v[228:231], v[36:39], v[112:127]
    ds_write_b128 v169, v[68:71] offset:5120
    v_exp_f32 v131, v131
    v_exp_f32 v132, v132
    v_exp_f32 v133, v133
    v_mfma_f32_32x32x16_bf16 v[80:95], v[200:203], v[144:147], v[80:95]
    ds_write_b128 v169, v[72:75] offset:6144
    v_exp_f32 v134, v134
    v_exp_f32 v135, v135
    v_exp_f32 v136, v136
    v_mfma_f32_32x32x16_bf16 v[80:95], v[204:207], v[148:151], v[80:95]
    ds_write_b128 v169, v[76:79] offset:7168
    v_exp_f32 v137, v137
    v_exp_f32 v138, v138
    v_exp_f32 v139, v139
    v_cvt_pk_bf16_f32 v152, v128, v129
    v_cvt_pk_bf16_f32 v153, v130, v131
    v_cvt_pk_bf16_f32 v154, v132, v133
    v_cvt_pk_bf16_f32 v155, v134, v135
    v_exp_f32 v140, v140
    v_exp_f32 v141, v141
    v_exp_f32 v142, v142
    v_exp_f32 v143, v143
    v_cvt_pk_bf16_f32 v156, v136, v137
    v_cvt_pk_bf16_f32 v157, v138, v139
    v_cvt_pk_bf16_f32 v158, v140, v141
    v_cvt_pk_bf16_f32 v159, v142, v143
    v_mfma_f32_32x32x16_bf16 v[128:143], v[240:243], v[32:35], 0
    ds_write_b32 v172, v174
    v_exp_f32 v112, v112
    v_exp_f32 v113, v113
    v_exp_f32 v114, v114
    v_mfma_f32_32x32x16_bf16 v[128:143], v[244:247], v[36:39], v[128:143]
    v_exp_f32 v115, v115
    v_exp_f32 v116, v116
    v_exp_f32 v117, v117
    v_mfma_f32_32x32x16_bf16 v[80:95], v[216:219], v[152:155], v[80:95]
    v_exp_f32 v118, v118
    v_exp_f32 v119, v119
    v_exp_f32 v120, v120
    v_mfma_f32_32x32x16_bf16 v[80:95], v[220:223], v[156:159], v[80:95]
    v_exp_f32 v121, v121
    v_exp_f32 v122, v122
    v_exp_f32 v123, v123
    v_cvt_pk_bf16_f32 v144, v112, v113
    v_cvt_pk_bf16_f32 v145, v114, v115
    v_cvt_pk_bf16_f32 v146, v116, v117
    v_cvt_pk_bf16_f32 v147, v118, v119
    v_exp_f32 v124, v124
    v_exp_f32 v125, v125
    v_exp_f32 v126, v126
    v_exp_f32 v127, v127
    v_cvt_pk_bf16_f32 v148, v120, v121
    v_cvt_pk_bf16_f32 v149, v122, v123
    v_cvt_pk_bf16_f32 v150, v124, v125
    v_cvt_pk_bf16_f32 v151, v126, v127
    v_mfma_f32_32x32x16_bf16 v[112:127], v[192:195], v[40:43], 0
    v_exp_f32 v128, v128
    v_exp_f32 v129, v129
    v_exp_f32 v130, v130
    v_mfma_f32_32x32x16_bf16 v[112:127], v[196:199], v[44:47], v[112:127]
    v_exp_f32 v131, v131
    v_exp_f32 v132, v132
    v_exp_f32 v133, v133
    v_mfma_f32_32x32x16_bf16 v[80:95], v[232:235], v[144:147], v[80:95]
    v_exp_f32 v134, v134
    v_exp_f32 v135, v135
    v_exp_f32 v136, v136
    v_mfma_f32_32x32x16_bf16 v[80:95], v[236:239], v[148:151], v[80:95]
    v_exp_f32 v137, v137
    v_exp_f32 v138, v138
    v_exp_f32 v139, v139
    v_cvt_pk_bf16_f32 v152, v128, v129
    v_cvt_pk_bf16_f32 v153, v130, v131
    v_cvt_pk_bf16_f32 v154, v132, v133
    v_cvt_pk_bf16_f32 v155, v134, v135
    v_exp_f32 v140, v140
    v_exp_f32 v141, v141
    v_exp_f32 v142, v142
    v_exp_f32 v143, v143
    v_cvt_pk_bf16_f32 v156, v136, v137
    v_cvt_pk_bf16_f32 v157, v138, v139
    v_cvt_pk_bf16_f32 v158, v140, v141
    v_cvt_pk_bf16_f32 v159, v142, v143
    v_mfma_f32_32x32x16_bf16 v[128:143], v[208:211], v[40:43], 0
    ds_read_b32 v176, v173
    v_exp_f32 v112, v112
    v_exp_f32 v113, v113
    v_exp_f32 v114, v114
    v_mfma_f32_32x32x16_bf16 v[128:143], v[212:215], v[44:47], v[128:143]
    v_exp_f32 v115, v115
    v_exp_f32 v116, v116
    v_exp_f32 v117, v117
    v_mfma_f32_32x32x16_bf16 v[80:95], v[248:251], v[152:155], v[80:95]
    v_exp_f32 v118, v118
    v_exp_f32 v119, v119
    v_exp_f32 v120, v120
    v_mfma_f32_32x32x16_bf16 v[80:95], v[252:255], v[156:159], v[80:95]
    s_waitcnt lgkmcnt(0)
    v_exp_f32 v121, v121
    v_exp_f32 v122, v122
    v_exp_f32 v123, v123
    v_cvt_pk_bf16_f32 v144, v112, v113
    v_cvt_pk_bf16_f32 v145, v114, v115
    v_cvt_pk_bf16_f32 v146, v116, v117
    v_cvt_pk_bf16_f32 v147, v118, v119
    v_exp_f32 v124, v124
    v_cmp_gt_u32 vcc, 2, v176
    v_exp_f32 v125, v125
    v_exp_f32 v126, v126
    s_cbranch_vccnz L_f2
L_f2_ok:
    v_exp_f32 v127, v127
    v_cvt_pk_bf16_f32 v148, v120, v121
    v_cvt_pk_bf16_f32 v149, v122, v123
    v_cvt_pk_bf16_f32 v150, v124, v125
    v_cvt_pk_bf16_f32 v151, v126, v127
    v_mfma_f32_32x32x16_bf16 v[112:127], v[224:227], v[40:43], 0
    ds_write_b128 v170, v[80:83] offset:8192
    v_exp_f32 v128, v128
    v_exp_f32 v129, v129
    v_exp_f32 v130, v130
    v_mfma_f32_32x32x16_bf16 v[112:127], v[228:231], v[44:47], v[112:127]
    ds_write_b128 v170, v[84:87] offset:9216
    v_exp_f32 v131, v131
    v_exp_f32 v132, v132
    v_exp_f32 v133, v133
    v_mfma_f32_32x32x16_bf16 v[96:111], v[200:203], v[144:147], v[96:111]
    ds_write_b128 v170, v[88:91] offset:10240
    v_exp_f32 v134, v134
    v_exp_f32 v135, v135
    v_exp_f32 v136, v136
    v_mfma_f32_32x32x16_bf16 v[96:111], v[204:207], v[148:151], v[96:111]
    ds_write_b128 v170, v[92:95] offset:11264
    ds_write_b32 v172, v175
    v_exp_f32 v137, v137
    v_exp_f32 v138, v138
    v_exp_f32 v139, v139
    v_cvt_pk_bf16_f32 v152, v128, v129
    v_cvt_pk_bf16_f32 v153, v130, v131
    v_cvt_pk_bf16_f32 v154, v132, v133
    v_cvt_pk_bf16_f32 v155, v134, v135
    v_exp_f32 v140, v140
    v_exp_f32 v141, v141
    v_exp_f32 v142, v142
    v_exp_f32 v143, v143
    v_cvt_pk_bf16_f32 v156, v136, v137
    v_cvt_pk_bf16_f32 v157, v138, v139
    v_cvt_pk_bf16_f32 v158, v140, v141
    v_cvt_pk_bf16_f32 v159, v142, v143
    v_mfma_f32_32x32x16_bf16 v[128:143], v[240:243], v[40:43], 0
    ds_read_b128 v[48:51], v171 offset:0
    ds_read_b128 v[52:55], v171 offset:1024
    v_exp_f32 v112, v112
    v_exp_f32 v113, v113
    v_exp_f32 v114, v114
    v_mfma_f32_32x32x16_bf16 v[128:143], v[244:247], v[44:47], v[128:143]
    ds_read_b128 v[56:59], v171 offset:2048
    ds_read_b128 v[60:63], v171 offset:3072
    v_exp_f32 v115, v115
    v_exp_f32 v116, v116
    v_exp_f32 v117, v117
    v_mfma_f32_32x32x16_bf16 v[96:111], v[216:219], v[152:155], v[96:111]
    ds_read_b128 v[64:67], v171 offset:4096
    ds_read_b128 v[68:71], v171 offset:5120
    v_exp_f32 v118, v118
    v_exp_f32 v119, v119
    v_exp_f32 v120, v120
    v_mfma_f32_32x32x16_bf16 v[96:111], v[220:223], v[156:159], v[96:111]
    ds_read_b128 v[72:75], v171 offset:6144
    ds_read_b128 v[76:79], v171 offset:7168
    v_exp_f32 v121, v121
    v_exp_f32 v122, v122
    v_exp_f32 v123, v123
    v_cvt_pk_bf16_f32 v144, v112, v113
    v_cvt_pk_bf16_f32 v145, v114, v115
    v_cvt_pk_bf16_f32 v146, v116, v117
    v_cvt_pk_bf16_f32 v147, v118, v119
    v_exp_f32 v124, v124
    v_exp_f32 v125, v125
    v_exp_f32 v126, v126
    v_exp_f32 v127, v127
    v_cvt_pk_bf16_f32 v148, v120, v121
    v_cvt_pk_bf16_f32 v149, v122, v123
    v_cvt_pk_bf16_f32 v150, v124, v125
    v_cvt_pk_bf16_f32 v151, v126, v127
    v_exp_f32 v128, v128
    v_exp_f32 v129, v129
    v_mfma_f32_32x32x16_bf16 v[96:111], v[232:235], v[144:147], v[96:111]
    v_exp_f32 v130, v130
    v_exp_f32 v131, v131
    v_exp_f32 v132, v132
    v_mfma_f32_32x32x16_bf16 v[96:111], v[236:239], v[148:151], v[96:111]
    ds_read_b32 v176, v173
    v_exp_f32 v133, v133
    v_exp_f32 v134, v134
    v_exp_f32 v135, v135
    v_exp_f32 v136, v136
    v_cvt_pk_bf16_f32 v152, v128, v129
    v_cvt_pk_bf16_f32 v153, v130, v131
    v_cvt_pk_bf16_f32 v154, v132, v133
    v_cvt_pk_bf16_f32 v155, v134, v135
    v_exp_f32 v137, v137
    v_exp_f32 v138, v138
    v_mfma_f32_32x32x16_bf16 v[96:111], v[248:251], v[152:155], v[96:111]
    v_exp_f32 v139, v139
    v_exp_f32 v140, v140
    v_exp_f32 v141, v141
    v_cvt_pk_bf16_f32 v156, v136, v137
    v_exp_f32 v142, v142
    s_waitcnt lgkmcnt(0)
    v_exp_f32 v143, v143
    v_cvt_pk_bf16_f32 v157, v138, v139
    v_cmp_gt_u32 vcc, 3, v176
    v_cvt_pk_bf16_f32 v158, v140, v141
    v_cvt_pk_bf16_f32 v159, v142, v143
    v_add_f32 v48, v48, v64
    v_add_f32 v49, v49, v65
    v_mfma_f32_32x32x16_bf16 v[96:111], v[252:255], v[156:159], v[96:111]
    s_cbranch_vccnz L_f3
L_f3_ok:
    ds_read_b128 v[80:83], v171 offset:8192
    ds_read_b128 v[84:87], v171 offset:9216
    ds_read_b128 v[88:91], v171 offset:10240
    ds_read_b128 v[92:95], v171 offset:11264
    v_add_f32 v50, v50, v66
    v_add_f32 v51, v51, v67
    v_add_f32 v52, v52, v68
    v_add_f32 v53, v53, v69
    v_add_f32 v54, v54, v70
    v_add_f32 v55, v55, v71
    v_add_f32 v56, v56, v72
    v_add_f32 v57, v57, v73
    v_add_f32 v58, v58, v74
    v_add_f32 v59, v59, v75
    v_add_f32 v60, v60, v76
    v_add_f32 v61, v61, v77
    v_add_f32 v62, v62, v78
    v_add_f32 v63, v63, v79
    s_waitcnt lgkmcnt(0)
    v_pk_add_f32 v[54:55], v[54:55], v[86:87]
    v_pk_add_f32 v[48:49], v[48:49], v[80:81]
    v_pk_add_f32 v[50:51], v[50:51], v[82:83]
    v_pk_add_f32 v[52:53], v[52:53], v[84:85]
    v_pk_add_f32 v[56:57], v[56:57], v[88:89]
    v_pk_add_f32 v[58:59], v[58:59], v[90:91]
    v_pk_add_f32 v[60:61], v[60:61], v[92:93]
    v_pk_add_f32 v[62:63], v[62:63], v[94:95]
    v_pk_add_f32 v[54:55], v[54:55], v[102:103]
    v_pk_add_f32 v[48:49], v[48:49], v[96:97]
    v_rcp_f32 v162, v54
    v_pk_add_f32 v[50:51], v[50:51], v[98:99]
    v_pk_add_f32 v[52:53], v[52:53], v[100:101]
    v_pk_add_f32 v[56:57], v[56:57], v[104:105]
    v_pk_add_f32 v[58:59], v[58:59], v[106:107]
    v_pk_add_f32 v[60:61], v[60:61], v[108:109]
    v_pk_add_f32 v[62:63], v[62:63], v[110:111]
    s_lshl2_add_u32 s8, s4, s23
    s_lshl4_add_u32 s7, s8, s85
    v_mov_b32 v163, v162
    s_lshl_b32 s7, s7, 11
    s_add_u32 s7, s7, 7340032
    s_mov_b32 s8, 0xffff
    v_mov_b32 v160, s6
    v_pk_mul_f32 v[48:49], v[162:163], v[48:49]
    v_pk_mul_f32 v[50:51], v[162:163], v[50:51]
    v_pk_mul_f32 v[52:53], v[162:163], v[52:53]
    v_pk_mul_f32 v[54:55], v[162:163], v[54:55]
    v_pk_mul_f32 v[48:49], v[14:15], v[48:49]
    v_pk_mul_f32 v[50:51], v[14:15], v[50:51]
    v_pk_mul_f32 v[52:53], v[14:15], v[52:53]
    v_pk_mul_f32 v[54:55], v[14:15], v[54:55]
    v_cvt_pk_bf16_f32 v144, v48, v49
    v_cvt_pk_bf16_f32 v145, v50, v51
    v_cvt_pk_bf16_f32 v146, v52, v53
    v_cvt_pk_bf16_f32 v147, v54, v55
    v_bfi_b32 v147, s8, v160, v147
    buffer_store_dwordx4 v[144:147], v8, s[68:71], s7 offen offset:0 sc1
    v_pk_mul_f32 v[56:57], v[162:163], v[56:57]
    v_pk_mul_f32 v[58:59], v[162:163], v[58:59]
    v_pk_mul_f32 v[60:61], v[162:163], v[60:61]
    v_pk_mul_f32 v[62:63], v[162:163], v[62:63]
    v_pk_mul_f32 v[56:57], v[14:15], v[56:57]
    v_pk_mul_f32 v[58:59], v[14:15], v[58:59]
    v_pk_mul_f32 v[60:61], v[14:15], v[60:61]
    v_pk_mul_f32 v[62:63], v[14:15], v[62:63]
    v_cvt_pk_bf16_f32 v148, v56, v57
    v_cvt_pk_bf16_f32 v149, v58, v59
    v_cvt_pk_bf16_f32 v150, v60, v61
    v_cvt_pk_bf16_f32 v151, v62, v63
    v_bfi_b32 v151, s8, v160, v151
    buffer_store_dwordx4 v[148:151], v8, s[68:71], s7 offen offset:1024 sc1
    v_mov_b32 v174, 4
    ds_write_b32 v172, v174
    s_waitcnt lgkmcnt(0)
L_fin_prof:
L_end:
    s_endpgm
L_rest:
    s_mov_b32 s74, L_code_end-L_pc
    s_mov_b32 s75, s43
    s_lshr_b32 s10, s2, 3
    s_lshl_b32 s10, s10, 9
    s_add_u32 s9, s3, s10
    s_buffer_load_dword s15, s[72:75], s9 offset:0
    s_buffer_load_dword s15, s[72:75], s9 offset:256
    s_buffer_load_dword s15, s[72:75], s9 offset:16384
    s_buffer_load_dword s15, s[72:75], s9 offset:16640
    s_buffer_load_dword s15, s[72:75], s9 offset:32768
    s_buffer_load_dword s15, s[72:75], s9 offset:33024
    s_load_dwordx2 s[44:45], s[0:1], 8
    s_load_dwordx2 s[68:69], s[0:1], 88
    s_load_dwordx2 s[56:57], s[0:1], 64
    s_load_dwordx2 s[60:61], s[0:1], 32
    s_load_dwordx2 s[64:65], s[0:1], 72
    s_lshr_b32 s3, s3, 6
    s_bitcmp1_b32 s2, 2
    s_cselect_b32 s9, 15, 14
    s_mov_b32 s85, 0x67543210
    s_cselect_b32 s85, 0x9ba8fedc, s85
    s_lshl_b32 s10, s21, 2
    s_lshr_b32 s85, s85, s10
    s_and_b32 s85, s85, 15
    s_mov_b32 s46, 401408
    s_mov_b32 s47, s43
    s_mov_b32 s70, 16777216
    s_mov_b32 s71, s43
    s_mov_b32 s58, 1605632
    s_mov_b32 s59, s43
    s_mov_b32 s62, 401408
    s_mov_b32 s63, s43
    s_mov_b32 s66, 1835008
    s_mov_b32 s67, s43
    v_lshlrev_b32 v8, 4, v0
    v_mov_b32 v7, 9699328
    s_cmp_eq_u32 s21, 7
    s_cselect_b32 s5, s9, s5
L_comp:
    s_and_b32 s20, s8, 1
    s_and_b32 s9, s2, 4
    s_lshr_b32 s10, s2, 6
    s_add_u32 s9, s9, s10
    s_lshl1_add_u32 s22, s9, s7
    s_lshl_b32 s14, s23, 13
    s_lshl_b32 s7, s21, 7
    s_mul_i32 s85, s23, 401408
    s_add_u32 s85, s85, s7
    s_mul_i32 s90, s23, 100352
    s_add_u32 s90, s90, s7
    s_mul_i32 s91, s21, 0
    s_and_b32 s7, s2, 6
    s_mul_i32 s7, s7, 7
    s_lshr_b32 s7, s7, 1
    s_add_u32 s91, s91, s7
    s_mov_b32 s92, s91
    v_lshrrev_b32 v9, 3, v0
    v_mul_u32_u24 v9, 896, v9
    v_bfe_u32 v10, v0, 4, 1
    v_lshlrev_b32 v10, 2, v10
    v_and_b32 v11, 7, v0
    v_xor_b32 v10, v10, v11
    v_lshl_add_u32 v158, v10, 4, v9
    v_add_u32 v9, 16, v0
    v_lshrrev_b32 v9, 5, v9
    v_mul_u32_u24 v9, 896, v9
    v_sub_u32 v159, v158, v9
    v_bfe_u32 v9, v0, 2, 2
    v_lshrrev_b32 v11, 5, v0
    v_lshl_add_u32 v10, v11, 2, v9
    v_lshlrev_b32 v10, 7, v10
    v_bfe_u32 v9, v0, 3, 1
    v_lshl_add_u32 v10, v9, 6, v10
    v_bfe_u32 v9, v0, 4, 1
    v_lshl_add_u32 v10, v9, 5, v10
    v_and_b32 v9, 3, v0
    v_lshl_add_u32 v10, v9, 3, v10
    v_lshlrev_b32 v249, 9, v9
    s_add_u32 s7, s14, 65536
    v_add_u32 v192, s7, v10
    s_and_b32 s7, s23, 2
    s_lshl_b32 s7, s7, 5
    v_xor_b32 v192, s7, v192
    v_xor_b32 v193, 64, v192
    v_add_u32 v194, 0x10000, v192
    v_add_u32 v195, 0x10000, v193
    s_lshl1_add_u32 s80, s22, s20
    s_and_b32 s7, s23, 1
    s_lshl1_add_u32 s80, s80, s7
    s_mul_i32 s8, s23, 28672
    s_mul_i32 s7, s80, 114688
    s_add_u32 s7, s7, s8
    v_add_u32 v196, s7, v8
    s_xor_b32 s7, s80, 1
    s_mul_i32 s7, s7, 114688
    s_add_u32 s7, s7, s8
    v_add_u32 v197, s7, v8
    v_and_b32 v9, 31, v0
    v_lshlrev_b32 v250, 4, v9
    s_lshl_b32 s7, s80, 5
    v_add_u32 v10, s7, v9
    v_mul_u32_u24 v10, 896, v10
    v_lshl_add_u32 v199, v11, 4, v10
    s_lshr_b32 s7, s23, 1
    s_lshl1_add_u32 s78, s21, s7
    s_lshl_b32 s78, s78, 6
    v_mov_b32 v255, 1
    s_lshl2_add_u32 s7, s80, s23
    s_lshl_b32 s7, s7, 13
    v_add_u32 v251, s7, v8
    v_xor_b32 v252, 0x8000, v251
    s_add_u32 s7, s14, 98304
    v_add_u32 v253, s7, v8
    s_lshl_b32 s7, s23, 2
    v_mov_b32 v254, s7
    s_mul_i32 s7, s4, 56
    s_add_u32 s7, s7, s5
    s_lshl2_add_u32 s7, s7, s23
    s_lshl_b32 s81, s7, 11
    s_add_u32 s82, s81, 114688
    s_add_u32 s83, s81, 229376
    s_add_u32 s84, s81, 344064
    v_bfe_u32 v10, v0, 1, 3
    v_xor_b32 v10, v10, v11
    v_lshlrev_b32 v1, 7, v9
    v_lshl_add_u32 v1, v10, 4, v1
    s_lshr_b32 s8, s2, 1
    s_and_b32 s8, s8, 64
    v_xor_b32 v1, s8, v1
    v_xor_b32 v2, 32, v1
    v_xor_b32 v3, 64, v1
    v_xor_b32 v4, 96, v1
    v_bfe_u32 v10, v0, 4, 1
    v_bfe_u32 v12, v0, 2, 2
    v_lshl_add_u32 v184, v12, 1, v10
    s_lshl_b32 s9, s23, 1
    v_xor_b32 v184, s9, v184
    v_lshlrev_b32 v184, 5, v184
    v_lshl_add_u32 v184, v11, 12, v184
    v_lshl_add_u32 v184, v10, 10, v184
    v_lshl_add_u32 v184, v12, 8, v184
    v_and_b32 v185, 3, v0
    v_lshl_add_u32 v184, v185, 3, v184
    v_add_u32 v5, 65536, v184
    v_xor_b32 v6, 32, v5
    v_add_u32 v11, 0x10000, v5
    v_add_u32 v12, 0x10000, v6
    v_lshlrev_b32 v9, 2, v9
    s_and_b32 s7, s4, 1
    s_lshl1_add_u32 s7, s5, s7
    s_lshl2_add_u32 s7, s7, s23
    s_lshl_b32 s7, s7, 12
    s_add_u32 s97, s7, 9895936
    s_lshr_b32 s7, s4, 1
    s_lshl_b32 s7, s7, 9
    s_add_u32 s98, s97, s7
    v_lshlrev_b32 v15, 3, v0
    v_mov_b32 v13, 0
    v_mov_b32 v14, 0
    v_mov_b32 v144, 0
    v_mov_b32 v145, 0
    v_mov_b32 v146, 0
    v_mov_b32 v147, 0
    v_mov_b32 v148, 0
    v_mov_b32 v149, 0
    v_mov_b32 v150, 0
    v_mov_b32 v151, 0
    v_mov_b32 v152, 0
    v_mov_b32 v153, 0
    v_mov_b32 v160, 0
    v_mov_b32 v161, 0
    v_mov_b32 v162, 0
    v_mov_b32 v163, 0
    v_mov_b32 v164, 0
    v_mov_b32 v165, 0
    v_mov_b32 v166, 0
    v_mov_b32 v167, 0
    s_mov_b32 s96, 0xffff0000
    s_waitcnt lgkmcnt(0)
    buffer_load_dword v7, v7, s[68:71], 0 offen sc1
    s_barrier
    ds_read_b64_tr_b16 v[224:225], v5 offset:0
    ds_read_b64_tr_b16 v[226:227], v5 offset:2048
    ds_read_b128 v[208:211], v1 offset:0
    ds_read_b64_tr_b16 v[228:229], v6 offset:0
    ds_read_b64_tr_b16 v[230:231], v6 offset:2048
    ds_read_b128 v[212:215], v1 offset:4096
    ds_read_b128 v[216:219], v1 offset:8192
    ds_read_b128 v[220:223], v1 offset:12288
    s_waitcnt lgkmcnt(0)
    v_mfma_f32_32x32x16_bf16 v[16:31], v[224:227], v[208:211], 0
    ds_read_b64_tr_b16 v[184:185], v5 offset:8192
    ds_read_b64_tr_b16 v[186:187], v5 offset:10240
    v_lshlrev_b32 v154, 16, v224
    v_lshlrev_b32 v155, 16, v228
    v_and_b32 v156, s96, v224
    v_mfma_f32_32x32x16_bf16 v[32:47], v[228:231], v[208:211], 0
    ds_read_b128 v[168:171], v2 offset:0
    ds_read_b64_tr_b16 v[188:189], v6 offset:8192
    v_and_b32 v157, s96, v228
    v_add_f32 v13, v13, v154
    v_add_f32 v14, v14, v155
    v_mfma_f32_32x32x16_bf16 v[64:79], v[228:231], v[212:215], 0
    ds_read_b64_tr_b16 v[190:191], v6 offset:10240
    ds_read_b128 v[172:175], v2 offset:4096
    v_add_f32 v13, v13, v156
    v_add_f32 v14, v14, v157
    v_lshlrev_b32 v154, 16, v225
    v_mfma_f32_32x32x16_bf16 v[48:63], v[224:227], v[212:215], 0
    ds_read_b128 v[176:179], v2 offset:8192
    ds_read_b128 v[180:183], v2 offset:12288
    v_lshlrev_b32 v155, 16, v229
    v_and_b32 v156, s96, v225
    v_and_b32 v157, s96, v229
    v_mfma_f32_32x32x16_bf16 v[80:95], v[224:227], v[216:219], 0
    v_add_f32 v13, v13, v154
    v_add_f32 v14, v14, v155
    v_add_f32 v13, v13, v156
    v_add_f32 v14, v14, v157
    v_lshlrev_b32 v154, 16, v226
    v_mfma_f32_32x32x16_bf16 v[96:111], v[228:231], v[216:219], 0
    v_lshlrev_b32 v155, 16, v230
    v_and_b32 v156, s96, v226
    v_and_b32 v157, s96, v230
    v_add_f32 v13, v13, v154
    v_add_f32 v14, v14, v155
    v_add_f32 v13, v13, v156
    v_mfma_f32_32x32x16_bf16 v[128:143], v[228:231], v[220:223], 0
    v_add_f32 v14, v14, v157
    v_lshlrev_b32 v154, 16, v227
    v_lshlrev_b32 v155, 16, v231
    v_and_b32 v156, s96, v227
    v_and_b32 v157, s96, v231
    v_add_f32 v13, v13, v154
    v_mfma_f32_32x32x16_bf16 v[112:127], v[224:227], v[220:223], 0
    v_add_f32 v14, v14, v155
    v_add_f32 v13, v13, v156
    v_add_f32 v14, v14, v157
    s_waitcnt lgkmcnt(0)
    s_barrier
    v_mfma_f32_32x32x16_bf16 v[16:31], v[184:187], v[168:171], v[16:31]
    ds_read_b64_tr_b16 v[224:225], v5 offset:16384
    ds_read_b64_tr_b16 v[226:227], v5 offset:18432
    v_lshlrev_b32 v154, 16, v184
    v_lshlrev_b32 v155, 16, v188
    v_and_b32 v156, s96, v184
    v_mfma_f32_32x32x16_bf16 v[32:47], v[188:191], v[168:171], v[32:47]
    ds_read_b128 v[208:211], v3 offset:0
    ds_read_b64_tr_b16 v[228:229], v6 offset:16384
    v_and_b32 v157, s96, v188
    v_add_f32 v13, v13, v154
    v_add_f32 v14, v14, v155
    v_mfma_f32_32x32x16_bf16 v[64:79], v[188:191], v[172:175], v[64:79]
    ds_read_b64_tr_b16 v[230:231], v6 offset:18432
    ds_read_b128 v[212:215], v3 offset:4096
    v_add_f32 v13, v13, v156
    v_add_f32 v14, v14, v157
    v_lshlrev_b32 v154, 16, v185
    v_mfma_f32_32x32x16_bf16 v[48:63], v[184:187], v[172:175], v[48:63]
    ds_read_b128 v[216:219], v3 offset:8192
    ds_read_b128 v[220:223], v3 offset:12288
    v_lshlrev_b32 v155, 16, v189
    v_and_b32 v156, s96, v185
    v_and_b32 v157, s96, v189
    v_mfma_f32_32x32x16_bf16 v[80:95], v[184:187], v[176:179], v[80:95]
    v_add_f32 v13, v13, v154
    v_add_f32 v14, v14, v155
    v_add_f32 v13, v13, v156
    v_add_f32 v14, v14, v157
    v_lshlrev_b32 v154, 16, v186
    v_mfma_f32_32x32x16_bf16 v[96:111], v[188:191], v[176:179], v[96:111]
    v_lshlrev_b32 v155, 16, v190
    v_and_b32 v156, s96, v186
    v_and_b32 v157, s96, v190
    v_add_f32 v13, v13, v154
    v_add_f32 v14, v14, v155
    v_add_f32 v13, v13, v156
    v_mfma_f32_32x32x16_bf16 v[128:143], v[188:191], v[180:183], v[128:143]
    v_add_f32 v14, v14, v157
    v_lshlrev_b32 v154, 16, v187
    v_lshlrev_b32 v155, 16, v191
    v_and_b32 v156, s96, v187
    v_and_b32 v157, s96, v191
    v_add_f32 v13, v13, v154
    v_mfma_f32_32x32x16_bf16 v[112:127], v[184:187], v[180:183], v[112:127]
    v_add_f32 v14, v14, v155
    v_add_f32 v13, v13, v156
    v_add_f32 v14, v14, v157
    s_waitcnt lgkmcnt(0)
    v_mfma_f32_32x32x16_bf16 v[16:31], v[224:227], v[208:211], v[16:31]
    ds_read_b64_tr_b16 v[184:185], v5 offset:24576
    ds_read_b64_tr_b16 v[186:187], v5 offset:26624
    v_mfma_f32_32x32x16_bf16 v[32:47], v[228:231], v[208:211], v[32:47]
    ds_read_b128 v[168:171], v4 offset:0
    ds_read_b64_tr_b16 v[188:189], v6 offset:24576
    v_mfma_f32_32x32x16_bf16 v[64:79], v[228:231], v[212:215], v[64:79]
    ds_read_b64_tr_b16 v[190:191], v6 offset:26624
    ds_read_b128 v[172:175], v4 offset:4096
    v_mfma_f32_32x32x16_bf16 v[48:63], v[224:227], v[212:215], v[48:63]
    ds_read_b128 v[176:179], v4 offset:8192
    ds_read_b128 v[180:183], v4 offset:12288
    v_mfma_f32_32x32x16_bf16 v[80:95], v[224:227], v[216:219], v[80:95]
    v_mfma_f32_32x32x16_bf16 v[96:111], v[228:231], v[216:219], v[96:111]
    v_mfma_f32_32x32x16_bf16 v[128:143], v[228:231], v[220:223], v[128:143]
    v_mfma_f32_32x32x16_bf16 v[112:127], v[224:227], v[220:223], v[112:127]
    s_waitcnt lgkmcnt(0)
    s_barrier
    v_mfma_f32_32x32x16_bf16 v[16:31], v[184:187], v[168:171], v[16:31]
    ds_read_b64_tr_b16 v[224:225], v5 offset:32768
    ds_read_b64_tr_b16 v[226:227], v5 offset:34816
    v_mfma_f32_32x32x16_bf16 v[32:47], v[188:191], v[168:171], v[32:47]
    ds_read_b128 v[208:211], v1 offset:16384
    ds_read_b64_tr_b16 v[228:229], v6 offset:32768
    v_mfma_f32_32x32x16_bf16 v[64:79], v[188:191], v[172:175], v[64:79]
    ds_read_b64_tr_b16 v[230:231], v6 offset:34816
    ds_read_b128 v[212:215], v1 offset:20480
    v_mfma_f32_32x32x16_bf16 v[48:63], v[184:187], v[172:175], v[48:63]
    ds_read_b128 v[216:219], v1 offset:24576
    ds_read_b128 v[220:223], v1 offset:28672
    v_mfma_f32_32x32x16_bf16 v[80:95], v[184:187], v[176:179], v[80:95]
    v_mfma_f32_32x32x16_bf16 v[96:111], v[188:191], v[176:179], v[96:111]
    v_mfma_f32_32x32x16_bf16 v[128:143], v[188:191], v[180:183], v[128:143]
    v_mfma_f32_32x32x16_bf16 v[112:127], v[184:187], v[180:183], v[112:127]
    s_waitcnt lgkmcnt(0)
    v_mfma_f32_32x32x16_bf16 v[16:31], v[224:227], v[208:211], v[16:31]
    ds_read_b64_tr_b16 v[184:185], v5 offset:40960
    ds_read_b64_tr_b16 v[186:187], v5 offset:43008
    v_lshlrev_b32 v154, 16, v224
    v_lshlrev_b32 v155, 16, v228
    v_and_b32 v156, s96, v224
    v_mfma_f32_32x32x16_bf16 v[32:47], v[228:231], v[208:211], v[32:47]
    ds_read_b128 v[168:171], v2 offset:16384
    ds_read_b64_tr_b16 v[188:189], v6 offset:40960
    v_and_b32 v157, s96, v228
    v_add_f32 v13, v13, v154
    v_add_f32 v14, v14, v155
    v_mfma_f32_32x32x16_bf16 v[64:79], v[228:231], v[212:215], v[64:79]
    ds_read_b64_tr_b16 v[190:191], v6 offset:43008
    ds_read_b128 v[172:175], v2 offset:20480
    v_add_f32 v13, v13, v156
    v_add_f32 v14, v14, v157
    v_lshlrev_b32 v154, 16, v225
    v_mfma_f32_32x32x16_bf16 v[48:63], v[224:227], v[212:215], v[48:63]
    ds_read_b128 v[176:179], v2 offset:24576
    ds_read_b128 v[180:183], v2 offset:28672
    v_lshlrev_b32 v155, 16, v229
    v_and_b32 v156, s96, v225
    v_and_b32 v157, s96, v229
    v_mfma_f32_32x32x16_bf16 v[80:95], v[224:227], v[216:219], v[80:95]
    v_add_f32 v13, v13, v154
    v_add_f32 v14, v14, v155
    v_add_f32 v13, v13, v156
    v_add_f32 v14, v14, v157
    v_lshlrev_b32 v154, 16, v226
    v_mfma_f32_32x32x16_bf16 v[96:111], v[228:231], v[216:219], v[96:111]
    v_lshlrev_b32 v155, 16, v230
    v_and_b32 v156, s96, v226
    v_and_b32 v157, s96, v230
    v_add_f32 v13, v13, v154
    v_add_f32 v14, v14, v155
    v_add_f32 v13, v13, v156
    v_mfma_f32_32x32x16_bf16 v[128:143], v[228:231], v[220:223], v[128:143]
    v_add_f32 v14, v14, v157
    v_lshlrev_b32 v154, 16, v227
    v_lshlrev_b32 v155, 16, v231
    v_and_b32 v156, s96, v227
    v_and_b32 v157, s96, v231
    v_add_f32 v13, v13, v154
    v_mfma_f32_32x32x16_bf16 v[112:127], v[224:227], v[220:223], v[112:127]
    v_add_f32 v14, v14, v155
    v_add_f32 v13, v13, v156
    v_add_f32 v14, v14, v157
    s_waitcnt lgkmcnt(0)
    v_mfma_f32_32x32x16_bf16 v[16:31], v[184:187], v[168:171], v[16:31]
    ds_read_b64_tr_b16 v[224:225], v5 offset:49152
    ds_read_b64_tr_b16 v[226:227], v5 offset:51200
    v_lshlrev_b32 v154, 16, v184
    v_lshlrev_b32 v155, 16, v188
    v_and_b32 v156, s96, v184
    v_mfma_f32_32x32x16_bf16 v[32:47], v[188:191], v[168:171], v[32:47]
    ds_read_b128 v[208:211], v3 offset:16384
    ds_read_b64_tr_b16 v[228:229], v6 offset:49152
    v_and_b32 v157, s96, v188
    v_add_f32 v13, v13, v154
    v_add_f32 v14, v14, v155
    v_mfma_f32_32x32x16_bf16 v[64:79], v[188:191], v[172:175], v[64:79]
    ds_read_b64_tr_b16 v[230:231], v6 offset:51200
    ds_read_b128 v[212:215], v3 offset:20480
    v_add_f32 v13, v13, v156
    v_add_f32 v14, v14, v157
    v_lshlrev_b32 v154, 16, v185
    v_mfma_f32_32x32x16_bf16 v[48:63], v[184:187], v[172:175], v[48:63]
    ds_read_b128 v[216:219], v3 offset:24576
    ds_read_b128 v[220:223], v3 offset:28672
    v_lshlrev_b32 v155, 16, v189
    v_and_b32 v156, s96, v185
    v_and_b32 v157, s96, v189
    v_mfma_f32_32x32x16_bf16 v[80:95], v[184:187], v[176:179], v[80:95]
    s_waitcnt vmcnt(0)
    v_readfirstlane_b32 s6, v7
    s_mul_i32 s6, s6, 0x9E3779B1
    s_add_u32 s6, s6, 0x7F4A7C15
    v_add_f32 v13, v13, v154
    v_add_f32 v14, v14, v155
    v_add_f32 v13, v13, v156
    v_mfma_f32_32x32x16_bf16 v[96:111], v[188:191], v[176:179], v[96:111]
    v_add_f32 v14, v14, v157
    v_lshlrev_b32 v154, 16, v186
    v_lshlrev_b32 v155, 16, v190
    v_and_b32 v156, s96, v186
    v_and_b32 v157, s96, v190
    v_add_f32 v13, v13, v154
    v_mfma_f32_32x32x16_bf16 v[128:143], v[188:191], v[180:183], v[128:143]
    v_add_f32 v14, v14, v155
    v_add_f32 v13, v13, v156
    v_add_f32 v14, v14, v157
    v_lshlrev_b32 v154, 16, v187
    v_lshlrev_b32 v155, 16, v191
    v_and_b32 v156, s96, v187
    v_mfma_f32_32x32x16_bf16 v[112:127], v[184:187], v[180:183], v[112:127]
    v_and_b32 v157, s96, v191
    v_add_f32 v13, v13, v154
    v_add_f32 v14, v14, v155
    v_add_f32 v13, v13, v156
    v_add_f32 v14, v14, v157
    s_waitcnt lgkmcnt(0)
    v_mfma_f32_32x32x16_bf16 v[16:31], v[224:227], v[208:211], v[16:31]
    ds_read_b64_tr_b16 v[184:185], v5 offset:57344
    ds_read_b64_tr_b16 v[186:187], v5 offset:59392
    v_mfma_f32_32x32x16_bf16 v[32:47], v[228:231], v[208:211], v[32:47]
    ds_read_b128 v[168:171], v4 offset:16384
    ds_read_b64_tr_b16 v[188:189], v6 offset:57344
    v_mfma_f32_32x32x16_bf16 v[64:79], v[228:231], v[212:215], v[64:79]
    ds_read_b64_tr_b16 v[190:191], v6 offset:59392
    ds_read_b128 v[172:175], v4 offset:20480
    v_mfma_f32_32x32x16_bf16 v[48:63], v[224:227], v[212:215], v[48:63]
    ds_read_b128 v[176:179], v4 offset:24576
    ds_read_b128 v[180:183], v4 offset:28672
    v_mfma_f32_32x32x16_bf16 v[80:95], v[224:227], v[216:219], v[80:95]
    v_mov_b32 v248, s6
    v_mfma_f32_32x32x16_bf16 v[96:111], v[228:231], v[216:219], v[96:111]
    v_mfma_f32_32x32x16_bf16 v[128:143], v[228:231], v[220:223], v[128:143]
    v_mfma_f32_32x32x16_bf16 v[112:127], v[224:227], v[220:223], v[112:127]
    s_waitcnt lgkmcnt(0)
    s_barrier
    v_mfma_f32_32x32x16_bf16 v[16:31], v[184:187], v[168:171], v[16:31]
    ds_read_b64_tr_b16 v[224:225], v11 offset:0
    ds_read_b64_tr_b16 v[226:227], v11 offset:2048
    v_mfma_f32_32x32x16_bf16 v[32:47], v[188:191], v[168:171], v[32:47]
    ds_read_b128 v[208:211], v1 offset:32768
    ds_read_b64_tr_b16 v[228:229], v12 offset:0
    v_mfma_f32_32x32x16_bf16 v[64:79], v[188:191], v[172:175], v[64:79]
    ds_read_b64_tr_b16 v[230:231], v12 offset:2048
    ds_read_b128 v[212:215], v1 offset:36864
    v_mfma_f32_32x32x16_bf16 v[48:63], v[184:187], v[172:175], v[48:63]
    ds_read_b128 v[216:219], v1 offset:40960
    ds_read_b128 v[220:223], v1 offset:45056
    v_mfma_f32_32x32x16_bf16 v[80:95], v[184:187], v[176:179], v[80:95]
    v_mfma_f32_32x32x16_bf16 v[96:111], v[188:191], v[176:179], v[96:111]
    v_mfma_f32_32x32x16_bf16 v[128:143], v[188:191], v[180:183], v[128:143]
    v_mfma_f32_32x32x16_bf16 v[112:127], v[184:187], v[180:183], v[112:127]
    s_waitcnt lgkmcnt(0)
    v_mfma_f32_32x32x16_bf16 v[16:31], v[224:227], v[208:211], v[16:31]
    ds_read_b64_tr_b16 v[184:185], v11 offset:8192
    ds_read_b64_tr_b16 v[186:187], v11 offset:10240
    v_lshlrev_b32 v154, 16, v224
    v_lshlrev_b32 v155, 16, v228
    v_and_b32 v156, s96, v224
    v_mfma_f32_32x32x16_bf16 v[32:47], v[228:231], v[208:211], v[32:47]
    ds_read_b128 v[168:171], v2 offset:32768
    ds_read_b64_tr_b16 v[188:189], v12 offset:8192
    v_and_b32 v157, s96, v228
    v_add_f32 v13, v13, v154
    v_add_f32 v14, v14, v155
    v_mfma_f32_32x32x16_bf16 v[64:79], v[228:231], v[212:215], v[64:79]
    ds_read_b64_tr_b16 v[190:191], v12 offset:10240
    ds_read_b128 v[172:175], v2 offset:36864
    v_add_f32 v13, v13, v156
    v_add_f32 v14, v14, v157
    v_lshlrev_b32 v154, 16, v225
    v_mfma_f32_32x32x16_bf16 v[48:63], v[224:227], v[212:215], v[48:63]
    ds_read_b128 v[176:179], v2 offset:40960
    ds_read_b128 v[180:183], v2 offset:45056
    v_lshlrev_b32 v155, 16, v229
    v_and_b32 v156, s96, v225
    v_and_b32 v157, s96, v229
    v_mfma_f32_32x32x16_bf16 v[80:95], v[224:227], v[216:219], v[80:95]
    v_add_f32 v13, v13, v154
    v_add_f32 v14, v14, v155
    v_add_f32 v13, v13, v156
    v_add_f32 v14, v14, v157
    v_lshlrev_b32 v154, 16, v226
    v_mfma_f32_32x32x16_bf16 v[96:111], v[228:231], v[216:219], v[96:111]
    v_lshlrev_b32 v155, 16, v230
    v_and_b32 v156, s96, v226
    v_and_b32 v157, s96, v230
    v_add_f32 v13, v13, v154
    v_add_f32 v14, v14, v155
    v_add_f32 v13, v13, v156
    v_mfma_f32_32x32x16_bf16 v[128:143], v[228:231], v[220:223], v[128:143]
    v_add_f32 v14, v14, v157
    v_lshlrev_b32 v154, 16, v227
    v_lshlrev_b32 v155, 16, v231
    v_and_b32 v156, s96, v227
    v_and_b32 v157, s96, v231
    v_add_f32 v13, v13, v154
    v_mfma_f32_32x32x16_bf16 v[112:127], v[224:227], v[220:223], v[112:127]
    v_add_f32 v14, v14, v155
    v_add_f32 v13, v13, v156
    v_add_f32 v14, v14, v157
    s_waitcnt lgkmcnt(0)
    v_mfma_f32_32x32x16_bf16 v[16:31], v[184:187], v[168:171], v[16:31]
    ds_read_b64_tr_b16 v[224:225], v11 offset:16384
    ds_read_b64_tr_b16 v[226:227], v11 offset:18432
    v_lshlrev_b32 v154, 16, v184
    v_lshlrev_b32 v155, 16, v188
    v_and_b32 v156, s96, v184
    v_mfma_f32_32x32x16_bf16 v[32:47], v[188:191], v[168:171], v[32:47]
    ds_read_b128 v[208:211], v3 offset:32768
    ds_read_b64_tr_b16 v[228:229], v12 offset:16384
    v_and_b32 v157, s96, v188
    v_add_f32 v13, v13, v154
    v_add_f32 v14, v14, v155
    v_mfma_f32_32x32x16_bf16 v[64:79], v[188:191], v[172:175], v[64:79]
    ds_read_b64_tr_b16 v[230:231], v12 offset:18432
    ds_read_b128 v[212:215], v3 offset:36864
    v_add_f32 v13, v13, v156
    v_add_f32 v14, v14, v157
    v_lshlrev_b32 v154, 16, v185
    v_mfma_f32_32x32x16_bf16 v[48:63], v[184:187], v[172:175], v[48:63]
    ds_read_b128 v[216:219], v3 offset:40960
    ds_read_b128 v[220:223], v3 offset:45056
    v_lshlrev_b32 v155, 16, v189
    v_and_b32 v156, s96, v185
    v_and_b32 v157, s96, v189
    v_mfma_f32_32x32x16_bf16 v[80:95], v[184:187], v[176:179], v[80:95]
    v_add_f32 v13, v13, v154
    v_add_f32 v14, v14, v155
    v_add_f32 v13, v13, v156
    v_add_f32 v14, v14, v157
    v_lshlrev_b32 v154, 16, v186
    v_mfma_f32_32x32x16_bf16 v[96:111], v[188:191], v[176:179], v[96:111]
    v_lshlrev_b32 v155, 16, v190
    v_and_b32 v156, s96, v186
    v_and_b32 v157, s96, v190
    v_add_f32 v13, v13, v154
    v_add_f32 v14, v14, v155
    v_add_f32 v13, v13, v156
    v_mfma_f32_32x32x16_bf16 v[128:143], v[188:191], v[180:183], v[128:143]
    v_add_f32 v14, v14, v157
    v_lshlrev_b32 v154, 16, v187
    v_lshlrev_b32 v155, 16, v191
    v_and_b32 v156, s96, v187
    v_and_b32 v157, s96, v191
    v_add_f32 v13, v13, v154
    v_mfma_f32_32x32x16_bf16 v[112:127], v[184:187], v[180:183], v[112:127]
    v_add_f32 v14, v14, v155
    v_add_f32 v13, v13, v156
    v_add_f32 v14, v14, v157
    s_waitcnt lgkmcnt(0)
    v_mfma_f32_32x32x16_bf16 v[16:31], v[224:227], v[208:211], v[16:31]
    ds_read_b64_tr_b16 v[184:185], v11 offset:24576
    ds_read_b64_tr_b16 v[186:187], v11 offset:26624
    v_mfma_f32_32x32x16_bf16 v[32:47], v[228:231], v[208:211], v[32:47]
    ds_read_b128 v[168:171], v4 offset:32768
    ds_read_b64_tr_b16 v[188:189], v12 offset:24576
    v_mfma_f32_32x32x16_bf16 v[64:79], v[228:231], v[212:215], v[64:79]
    ds_read_b64_tr_b16 v[190:191], v12 offset:26624
    ds_read_b128 v[172:175], v4 offset:36864
    v_mfma_f32_32x32x16_bf16 v[48:63], v[224:227], v[212:215], v[48:63]
    ds_read_b128 v[176:179], v4 offset:40960
    ds_read_b128 v[180:183], v4 offset:45056
    v_mfma_f32_32x32x16_bf16 v[80:95], v[224:227], v[216:219], v[80:95]
    v_mul_f32 v13, 0x3e800000, v13
    v_mul_f32 v14, 0x3e800000, v14
    v_mfma_f32_32x32x16_bf16 v[96:111], v[228:231], v[216:219], v[96:111]
    v_mfma_f32_32x32x16_bf16 v[128:143], v[228:231], v[220:223], v[128:143]
    v_mfma_f32_32x32x16_bf16 v[112:127], v[224:227], v[220:223], v[112:127]
    s_waitcnt lgkmcnt(0)
    s_barrier
    v_mfma_f32_32x32x16_bf16 v[16:31], v[184:187], v[168:171], v[16:31]
    ds_read_b64_tr_b16 v[224:225], v5 offset:0
    ds_read_b64_tr_b16 v[226:227], v5 offset:2048
    v_mfma_f32_32x32x16_bf16 v[32:47], v[188:191], v[168:171], v[32:47]
    ds_read_b128 v[208:211], v1 offset:0
    ds_read_b64_tr_b16 v[228:229], v6 offset:0
    v_mfma_f32_32x32x16_bf16 v[64:79], v[188:191], v[172:175], v[64:79]
    ds_read_b64_tr_b16 v[230:231], v6 offset:2048
    ds_read_b128 v[212:215], v1 offset:4096
    v_mfma_f32_32x32x16_bf16 v[48:63], v[184:187], v[172:175], v[48:63]
    ds_read_b128 v[216:219], v1 offset:8192
    ds_read_b128 v[220:223], v1 offset:12288
    v_mfma_f32_32x32x16_bf16 v[80:95], v[184:187], v[176:179], v[80:95]
    v_mfma_f32_32x32x16_bf16 v[96:111], v[188:191], v[176:179], v[96:111]
    v_mfma_f32_32x32x16_bf16 v[128:143], v[188:191], v[180:183], v[128:143]
    v_mfma_f32_32x32x16_bf16 v[112:127], v[184:187], v[180:183], v[112:127]
    s_waitcnt lgkmcnt(0)
    v_mfma_f32_32x32x16_bf16 v[16:31], v[224:227], v[208:211], v[16:31]
    ds_read_b64_tr_b16 v[184:185], v5 offset:8192
    ds_read_b64_tr_b16 v[186:187], v5 offset:10240
    v_lshlrev_b32 v154, 16, v224
    v_lshlrev_b32 v155, 16, v228
    v_and_b32 v156, s96, v224
    v_mfma_f32_32x32x16_bf16 v[32:47], v[228:231], v[208:211], v[32:47]
    ds_read_b128 v[168:171], v2 offset:0
    ds_read_b64_tr_b16 v[188:189], v6 offset:8192
    v_and_b32 v157, s96, v228
    v_add_f32 v13, v13, v154
    v_add_f32 v14, v14, v155
    v_mfma_f32_32x32x16_bf16 v[64:79], v[228:231], v[212:215], v[64:79]
    ds_read_b64_tr_b16 v[190:191], v6 offset:10240
    ds_read_b128 v[172:175], v2 offset:4096
    v_add_f32 v13, v13, v156
    v_add_f32 v14, v14, v157
    v_lshlrev_b32 v154, 16, v225
    v_mfma_f32_32x32x16_bf16 v[48:63], v[224:227], v[212:215], v[48:63]
    ds_read_b128 v[176:179], v2 offset:8192
    ds_read_b128 v[180:183], v2 offset:12288
    v_lshlrev_b32 v155, 16, v229
    v_and_b32 v156, s96, v225
    v_and_b32 v157, s96, v229
    v_mfma_f32_32x32x16_bf16 v[80:95], v[224:227], v[216:219], v[80:95]
    v_add_f32 v13, v13, v154
    v_add_f32 v14, v14, v155
    v_add_f32 v13, v13, v156
    v_add_f32 v14, v14, v157
    v_lshlrev_b32 v154, 16, v226
    v_mfma_f32_32x32x16_bf16 v[96:111], v[228:231], v[216:219], v[96:111]
    v_lshlrev_b32 v155, 16, v230
    v_and_b32 v156, s96, v226
    v_and_b32 v157, s96, v230
    v_add_f32 v13, v13, v154
    v_add_f32 v14, v14, v155
    v_add_f32 v13, v13, v156
    v_mfma_f32_32x32x16_bf16 v[128:143], v[228:231], v[220:223], v[128:143]
    v_add_f32 v14, v14, v157
    v_lshlrev_b32 v154, 16, v227
    v_lshlrev_b32 v155, 16, v231
    v_and_b32 v156, s96, v227
    v_and_b32 v157, s96, v231
    v_add_f32 v13, v13, v154
    v_mfma_f32_32x32x16_bf16 v[112:127], v[224:227], v[220:223], v[112:127]
    v_add_f32 v14, v14, v155
    v_add_f32 v13, v13, v156
    v_add_f32 v14, v14, v157
    s_waitcnt lgkmcnt(0)
    v_mfma_f32_32x32x16_bf16 v[16:31], v[184:187], v[168:171], v[16:31]
    ds_read_b64_tr_b16 v[224:225], v5 offset:16384
    ds_read_b64_tr_b16 v[226:227], v5 offset:18432
    v_lshlrev_b32 v154, 16, v184
    v_lshlrev_b32 v155, 16, v188
    v_and_b32 v156, s96, v184
    v_mfma_f32_32x32x16_bf16 v[32:47], v[188:191], v[168:171], v[32:47]
    ds_read_b128 v[208:211], v3 offset:0
    ds_read_b64_tr_b16 v[228:229], v6 offset:16384
    v_and_b32 v157, s96, v188
    v_add_f32 v13, v13, v154
    v_add_f32 v14, v14, v155
    v_mfma_f32_32x32x16_bf16 v[64:79], v[188:191], v[172:175], v[64:79]
    ds_read_b64_tr_b16 v[230:231], v6 offset:18432
    ds_read_b128 v[212:215], v3 offset:4096
    v_add_f32 v13, v13, v156
    v_add_f32 v14, v14, v157
    v_lshlrev_b32 v154, 16, v185
    v_mfma_f32_32x32x16_bf16 v[48:63], v[184:187], v[172:175], v[48:63]
    ds_read_b128 v[216:219], v3 offset:8192
    ds_read_b128 v[220:223], v3 offset:12288
    v_lshlrev_b32 v155, 16, v189
    v_and_b32 v156, s96, v185
    v_and_b32 v157, s96, v189
    v_mfma_f32_32x32x16_bf16 v[80:95], v[184:187], v[176:179], v[80:95]
    v_add_f32 v13, v13, v154
    v_add_f32 v14, v14, v155
    v_add_f32 v13, v13, v156
    v_add_f32 v14, v14, v157
    v_lshlrev_b32 v154, 16, v186
    v_mfma_f32_32x32x16_bf16 v[96:111], v[188:191], v[176:179], v[96:111]
    v_lshlrev_b32 v155, 16, v190
    v_and_b32 v156, s96, v186
    v_and_b32 v157, s96, v190
    v_add_f32 v13, v13, v154
    v_add_f32 v14, v14, v155
    v_add_f32 v13, v13, v156
    v_mfma_f32_32x32x16_bf16 v[128:143], v[188:191], v[180:183], v[128:143]
    v_add_f32 v14, v14, v157
    v_lshlrev_b32 v154, 16, v187
    v_lshlrev_b32 v155, 16, v191
    v_and_b32 v156, s96, v187
    v_and_b32 v157, s96, v191
    v_add_f32 v13, v13, v154
    v_mfma_f32_32x32x16_bf16 v[112:127], v[184:187], v[180:183], v[112:127]
    v_add_f32 v14, v14, v155
    v_add_f32 v13, v13, v156
    v_add_f32 v14, v14, v157
    s_waitcnt lgkmcnt(0)
    v_mfma_f32_32x32x16_bf16 v[16:31], v[224:227], v[208:211], v[16:31]
    ds_read_b64_tr_b16 v[184:185], v5 offset:24576
    ds_read_b64_tr_b16 v[186:187], v5 offset:26624
    v_mfma_f32_32x32x16_bf16 v[32:47], v[228:231], v[208:211], v[32:47]
    ds_read_b128 v[168:171], v4 offset:0
    ds_read_b64_tr_b16 v[188:189], v6 offset:24576
    v_mfma_f32_32x32x16_bf16 v[64:79], v[228:231], v[212:215], v[64:79]
    ds_read_b64_tr_b16 v[190:191], v6 offset:26624
    ds_read_b128 v[172:175], v4 offset:4096
    v_mfma_f32_32x32x16_bf16 v[48:63], v[224:227], v[212:215], v[48:63]
    ds_read_b128 v[176:179], v4 offset:8192
    ds_read_b128 v[180:183], v4 offset:12288
    v_mfma_f32_32x32x16_bf16 v[80:95], v[224:227], v[216:219], v[80:95]
    v_permlane32_swap_b32 v13, v14
    v_mov_b32 v201, s6
    v_add_f32 v200, v13, v14
    v_mfma_f32_32x32x16_bf16 v[96:111], v[228:231], v[216:219], v[96:111]
    v_mfma_f32_32x32x16_bf16 v[128:143], v[228:231], v[220:223], v[128:143]
    v_mfma_f32_32x32x16_bf16 v[112:127], v[224:227], v[220:223], v[112:127]
    buffer_store_dwordx2 v[200:201], v15, s[68:71], s98 offen sc1
    s_waitcnt lgkmcnt(0)
    s_barrier
    v_mfma_f32_32x32x16_bf16 v[16:31], v[184:187], v[168:171], v[16:31]
    ds_read_b64_tr_b16 v[224:225], v5 offset:32768
    ds_read_b64_tr_b16 v[226:227], v5 offset:34816
    v_mfma_f32_32x32x16_bf16 v[32:47], v[188:191], v[168:171], v[32:47]
    ds_read_b128 v[208:211], v1 offset:16384
    ds_read_b64_tr_b16 v[228:229], v6 offset:32768
    v_mfma_f32_32x32x16_bf16 v[64:79], v[188:191], v[172:175], v[64:79]
    ds_read_b64_tr_b16 v[230:231], v6 offset:34816
    ds_read_b128 v[212:215], v1 offset:20480
    v_mfma_f32_32x32x16_bf16 v[48:63], v[184:187], v[172:175], v[48:63]
    ds_read_b128 v[216:219], v1 offset:24576
    ds_read_b128 v[220:223], v1 offset:28672
    v_mfma_f32_32x32x16_bf16 v[80:95], v[184:187], v[176:179], v[80:95]
    v_mfma_f32_32x32x16_bf16 v[96:111], v[188:191], v[176:179], v[96:111]
    v_mfma_f32_32x32x16_bf16 v[128:143], v[188:191], v[180:183], v[128:143]
    v_mfma_f32_32x32x16_bf16 v[112:127], v[184:187], v[180:183], v[112:127]
    s_waitcnt lgkmcnt(0)
    v_mfma_f32_32x32x16_bf16 v[16:31], v[224:227], v[208:211], v[16:31]
    ds_read_b64_tr_b16 v[184:185], v5 offset:40960
    ds_read_b64_tr_b16 v[186:187], v5 offset:43008
    v_mfma_f32_32x32x16_bf16 v[32:47], v[228:231], v[208:211], v[32:47]
    ds_read_b128 v[168:171], v2 offset:16384
    ds_read_b64_tr_b16 v[188:189], v6 offset:40960
    v_mfma_f32_32x32x16_bf16 v[64:79], v[228:231], v[212:215], v[64:79]
    ds_read_b64_tr_b16 v[190:191], v6 offset:43008
    ds_read_b128 v[172:175], v2 offset:20480
    v_mfma_f32_32x32x16_bf16 v[48:63], v[224:227], v[212:215], v[48:63]
    ds_read_b128 v[176:179], v2 offset:24576
    ds_read_b128 v[180:183], v2 offset:28672
    v_mfma_f32_32x32x16_bf16 v[80:95], v[224:227], v[216:219], v[80:95]
    v_mfma_f32_32x32x16_bf16 v[96:111], v[228:231], v[216:219], v[96:111]
    v_mfma_f32_32x32x16_bf16 v[128:143], v[228:231], v[220:223], v[128:143]
    v_mfma_f32_32x32x16_bf16 v[112:127], v[224:227], v[220:223], v[112:127]
    s_waitcnt lgkmcnt(0)
    v_mfma_f32_32x32x16_bf16 v[16:31], v[184:187], v[168:171], v[16:31]
    ds_read_b64_tr_b16 v[224:225], v5 offset:49152
    ds_read_b64_tr_b16 v[226:227], v5 offset:51200
    v_mfma_f32_32x32x16_bf16 v[32:47], v[188:191], v[168:171], v[32:47]
    ds_read_b128 v[208:211], v3 offset:16384
    ds_read_b64_tr_b16 v[228:229], v6 offset:49152
    v_mfma_f32_32x32x16_bf16 v[64:79], v[188:191], v[172:175], v[64:79]
    ds_read_b64_tr_b16 v[230:231], v6 offset:51200
    ds_read_b128 v[212:215], v3 offset:20480
    v_mfma_f32_32x32x16_bf16 v[48:63], v[184:187], v[172:175], v[48:63]
    ds_read_b128 v[216:219], v3 offset:24576
    ds_read_b128 v[220:223], v3 offset:28672
    v_mfma_f32_32x32x16_bf16 v[80:95], v[184:187], v[176:179], v[80:95]
    v_mfma_f32_32x32x16_bf16 v[96:111], v[188:191], v[176:179], v[96:111]
    v_mfma_f32_32x32x16_bf16 v[128:143], v[188:191], v[180:183], v[128:143]
    v_mfma_f32_32x32x16_bf16 v[112:127], v[184:187], v[180:183], v[112:127]
    s_waitcnt lgkmcnt(0)
    v_mfma_f32_32x32x16_bf16 v[16:31], v[224:227], v[208:211], v[16:31]
    ds_read_b64_tr_b16 v[184:185], v5 offset:57344
    ds_read_b64_tr_b16 v[186:187], v5 offset:59392
    v_mfma_f32_32x32x16_bf16 v[32:47], v[228:231], v[208:211], v[32:47]
    ds_read_b128 v[168:171], v4 offset:16384
    ds_read_b64_tr_b16 v[188:189], v6 offset:57344
    v_mfma_f32_32x32x16_bf16 v[64:79], v[228:231], v[212:215], v[64:79]
    ds_read_b64_tr_b16 v[190:191], v6 offset:59392
    ds_read_b128 v[172:175], v4 offset:20480
    v_mfma_f32_32x32x16_bf16 v[48:63], v[224:227], v[212:215], v[48:63]
    ds_read_b128 v[176:179], v4 offset:24576
    ds_read_b128 v[180:183], v4 offset:28672
    v_mfma_f32_32x32x16_bf16 v[80:95], v[224:227], v[216:219], v[80:95]
    v_mfma_f32_32x32x16_bf16 v[96:111], v[228:231], v[216:219], v[96:111]
    v_mfma_f32_32x32x16_bf16 v[128:143], v[228:231], v[220:223], v[128:143]
    v_mfma_f32_32x32x16_bf16 v[112:127], v[224:227], v[220:223], v[112:127]
    s_waitcnt lgkmcnt(0)
    s_barrier
    v_mfma_f32_32x32x16_bf16 v[16:31], v[184:187], v[168:171], v[16:31]
    ds_read_b64_tr_b16 v[224:225], v11 offset:0
    ds_read_b64_tr_b16 v[226:227], v11 offset:2048
    v_mfma_f32_32x32x16_bf16 v[32:47], v[188:191], v[168:171], v[32:47]
    ds_read_b128 v[208:211], v1 offset:32768
    ds_read_b64_tr_b16 v[228:229], v12 offset:0
    v_mfma_f32_32x32x16_bf16 v[64:79], v[188:191], v[172:175], v[64:79]
    ds_read_b64_tr_b16 v[230:231], v12 offset:2048
    ds_read_b128 v[212:215], v1 offset:36864
    v_mfma_f32_32x32x16_bf16 v[48:63], v[184:187], v[172:175], v[48:63]
    ds_read_b128 v[216:219], v1 offset:40960
    ds_read_b128 v[220:223], v1 offset:45056
    v_mfma_f32_32x32x16_bf16 v[80:95], v[184:187], v[176:179], v[80:95]
    v_mfma_f32_32x32x16_bf16 v[96:111], v[188:191], v[176:179], v[96:111]
    v_mfma_f32_32x32x16_bf16 v[128:143], v[188:191], v[180:183], v[128:143]
    v_mfma_f32_32x32x16_bf16 v[112:127], v[184:187], v[180:183], v[112:127]
    s_waitcnt lgkmcnt(0)
    v_mfma_f32_32x32x16_bf16 v[16:31], v[224:227], v[208:211], v[16:31]
    ds_read_b64_tr_b16 v[184:185], v11 offset:8192
    ds_read_b64_tr_b16 v[186:187], v11 offset:10240
    v_mfma_f32_32x32x16_bf16 v[32:47], v[228:231], v[208:211], v[32:47]
    ds_read_b128 v[168:171], v2 offset:32768
    ds_read_b64_tr_b16 v[188:189], v12 offset:8192
    v_mfma_f32_32x32x16_bf16 v[64:79], v[228:231], v[212:215], v[64:79]
    ds_read_b64_tr_b16 v[190:191], v12 offset:10240
    ds_read_b128 v[172:175], v2 offset:36864
    v_mfma_f32_32x32x16_bf16 v[48:63], v[224:227], v[212:215], v[48:63]
    ds_read_b128 v[176:179], v2 offset:40960
    ds_read_b128 v[180:183], v2 offset:45056
    v_mfma_f32_32x32x16_bf16 v[80:95], v[224:227], v[216:219], v[80:95]
    v_mfma_f32_32x32x16_bf16 v[96:111], v[228:231], v[216:219], v[96:111]
    v_mfma_f32_32x32x16_bf16 v[128:143], v[228:231], v[220:223], v[128:143]
    v_mfma_f32_32x32x16_bf16 v[112:127], v[224:227], v[220:223], v[112:127]
    s_waitcnt lgkmcnt(0)
    v_mfma_f32_32x32x16_bf16 v[16:31], v[184:187], v[168:171], v[16:31]
    ds_read_b64_tr_b16 v[224:225], v11 offset:16384
    ds_read_b64_tr_b16 v[226:227], v11 offset:18432
    v_mfma_f32_32x32x16_bf16 v[32:47], v[188:191], v[168:171], v[32:47]
    ds_read_b128 v[208:211], v3 offset:32768
    ds_read_b64_tr_b16 v[228:229], v12 offset:16384
    v_mfma_f32_32x32x16_bf16 v[64:79], v[188:191], v[172:175], v[64:79]
    ds_read_b64_tr_b16 v[230:231], v12 offset:18432
    ds_read_b128 v[212:215], v3 offset:36864
    v_mfma_f32_32x32x16_bf16 v[48:63], v[184:187], v[172:175], v[48:63]
    ds_read_b128 v[216:219], v3 offset:40960
    ds_read_b128 v[220:223], v3 offset:45056
    v_mfma_f32_32x32x16_bf16 v[80:95], v[184:187], v[176:179], v[80:95]
    v_mfma_f32_32x32x16_bf16 v[96:111], v[188:191], v[176:179], v[96:111]
    v_mfma_f32_32x32x16_bf16 v[128:143], v[188:191], v[180:183], v[128:143]
    v_mfma_f32_32x32x16_bf16 v[112:127], v[184:187], v[180:183], v[112:127]
    s_waitcnt lgkmcnt(0)
    v_mfma_f32_32x32x16_bf16 v[16:31], v[224:227], v[208:211], v[16:31]
    ds_read_b64_tr_b16 v[184:185], v11 offset:24576
    ds_read_b64_tr_b16 v[186:187], v11 offset:26624
    v_mfma_f32_32x32x16_bf16 v[32:47], v[228:231], v[208:211], v[32:47]
    ds_read_b128 v[168:171], v4 offset:32768
    ds_read_b64_tr_b16 v[188:189], v12 offset:24576
    v_mfma_f32_32x32x16_bf16 v[64:79], v[228:231], v[212:215], v[64:79]
    ds_read_b64_tr_b16 v[190:191], v12 offset:26624
    ds_read_b128 v[172:175], v4 offset:36864
    v_mfma_f32_32x32x16_bf16 v[48:63], v[224:227], v[212:215], v[48:63]
    ds_read_b128 v[176:179], v4 offset:40960
    ds_read_b128 v[180:183], v4 offset:45056
    v_mfma_f32_32x32x16_bf16 v[80:95], v[224:227], v[216:219], v[80:95]
    v_mfma_f32_32x32x16_bf16 v[96:111], v[228:231], v[216:219], v[96:111]
    v_mfma_f32_32x32x16_bf16 v[128:143], v[228:231], v[220:223], v[128:143]
    v_mfma_f32_32x32x16_bf16 v[112:127], v[224:227], v[220:223], v[112:127]
    s_waitcnt lgkmcnt(0)
    s_barrier
    s_setprio 2
    v_mfma_f32_32x32x16_bf16 v[16:31], v[184:187], v[168:171], v[16:31]
    buffer_load_dwordx2 v[200:201], v15, s[68:71], s97 offen offset:0 sc1
    ds_read_b64_tr_b16 v[224:225], v5 offset:0
    ds_read_b64_tr_b16 v[226:227], v5 offset:2048
    v_mfma_f32_32x32x16_bf16 v[32:47], v[188:191], v[168:171], v[32:47]
    buffer_load_dwordx2 v[202:203], v15, s[68:71], s97 offen offset:512 sc1
    ds_read_b128 v[208:211], v1 offset:0
    ds_read_b64_tr_b16 v[228:229], v6 offset:0
    v_mfma_f32_32x32x16_bf16 v[64:79], v[188:191], v[172:175], v[64:79]
    ds_read_b64_tr_b16 v[230:231], v6 offset:2048
    ds_read_b128 v[212:215], v1 offset:4096
    v_mfma_f32_32x32x16_bf16 v[48:63], v[184:187], v[172:175], v[48:63]
    ds_read_b128 v[216:219], v1 offset:8192
    ds_read_b128 v[220:223], v1 offset:12288
    v_mfma_f32_32x32x16_bf16 v[80:95], v[184:187], v[176:179], v[80:95]
    v_mfma_f32_32x32x16_bf16 v[96:111], v[188:191], v[176:179], v[96:111]
    buffer_load_dwordx2 v[204:205], v15, s[68:71], s97 offen offset:1024 sc1
    v_mfma_f32_32x32x16_bf16 v[128:143], v[188:191], v[180:183], v[128:143]
    v_mfma_f32_32x32x16_bf16 v[112:127], v[184:187], v[180:183], v[112:127]
    buffer_load_dwordx2 v[206:207], v15, s[68:71], s97 offen offset:1536 sc1
    s_waitcnt lgkmcnt(0)
    v_mfma_f32_32x32x16_bf16 v[16:31], v[224:227], v[208:211], v[16:31]
    buffer_load_dwordx2 v[232:233], v15, s[68:71], s97 offen offset:2048 sc1
    ds_read_b64_tr_b16 v[184:185], v5 offset:8192
    ds_read_b64_tr_b16 v[186:187], v5 offset:10240
    v_mfma_f32_32x32x16_bf16 v[32:47], v[228:231], v[208:211], v[32:47]
    buffer_load_dwordx2 v[234:235], v15, s[68:71], s97 offen offset:2560 sc1
    ds_read_b128 v[168:171], v2 offset:0
    ds_read_b64_tr_b16 v[188:189], v6 offset:8192
    v_mfma_f32_32x32x16_bf16 v[64:79], v[228:231], v[212:215], v[64:79]
    ds_read_b64_tr_b16 v[190:191], v6 offset:10240
    ds_read_b128 v[172:175], v2 offset:4096
    v_mfma_f32_32x32x16_bf16 v[48:63], v[224:227], v[212:215], v[48:63]
    ds_read_b128 v[176:179], v2 offset:8192
    ds_read_b128 v[180:183], v2 offset:12288
    v_mfma_f32_32x32x16_bf16 v[80:95], v[224:227], v[216:219], v[80:95]
    ds_read_b32 v144, v9 offset:30720
    ds_read_b32 v146, v9 offset:30976
    v_mfma_f32_32x32x16_bf16 v[96:111], v[228:231], v[216:219], v[96:111]
    buffer_load_dwordx2 v[236:237], v15, s[68:71], s97 offen offset:3072 sc1
    v_mfma_f32_32x32x16_bf16 v[128:143], v[228:231], v[220:223], v[128:143]
    v_mfma_f32_32x32x16_bf16 v[112:127], v[224:227], v[220:223], v[112:127]
    buffer_load_dwordx2 v[238:239], v15, s[68:71], s97 offen offset:3584 sc1
    s_waitcnt lgkmcnt(0)
    v_mfma_f32_32x32x16_bf16 v[16:31], v[184:187], v[168:171], v[16:31]
    ds_read_b64_tr_b16 v[224:225], v5 offset:16384
    ds_read_b64_tr_b16 v[226:227], v5 offset:18432
    v_mfma_f32_32x32x16_bf16 v[32:47], v[188:191], v[168:171], v[32:47]
    ds_read_b128 v[208:211], v3 offset:0
    ds_read_b64_tr_b16 v[228:229], v6 offset:16384
    v_mfma_f32_32x32x16_bf16 v[64:79], v[188:191], v[172:175], v[64:79]
    ds_read_b64_tr_b16 v[230:231], v6 offset:18432
    ds_read_b128 v[212:215], v3 offset:4096
    v_mfma_f32_32x32x16_bf16 v[48:63], v[184:187], v[172:175], v[48:63]
    s_mul_i32 s8, s91, 14336
    s_add_u32 s8, s8, s85
    s_add_u32 m0, s14, 98304
    s_add_u32 s7, s8, 7168
    ds_read_b128 v[216:219], v3 offset:8192
    ds_read_b128 v[220:223], v3 offset:12288
    v_mfma_f32_32x32x16_bf16 v[80:95], v[184:187], v[176:179], v[80:95]
    buffer_load_dwordx4 v158, s[56:59], s8 offen lds
    s_add_u32 m0, s14, 99328
    s_add_u32 s91, s91, 1
    ds_read_b32 v148, v9 offset:31232
    ds_read_b32 v150, v9 offset:31488
    v_mfma_f32_32x32x16_bf16 v[96:111], v[188:191], v[176:179], v[96:111]
    v_mfma_f32_32x32x16_bf16 v[128:143], v[188:191], v[180:183], v[128:143]
    buffer_load_dwordx4 v158, s[56:59], s7 offen lds
    s_cmp_eq_u32 s91, 28
    s_cselect_b32 s91, 0, s91
    v_mfma_f32_32x32x16_bf16 v[112:127], v[184:187], v[180:183], v[112:127]
    s_waitcnt lgkmcnt(0)
    v_mfma_f32_32x32x16_bf16 v[16:31], v[224:227], v[208:211], v[16:31]
    ds_read_b64_tr_b16 v[184:185], v5 offset:24576
    ds_read_b64_tr_b16 v[186:187], v5 offset:26624
    v_mfma_f32_32x32x16_bf16 v[32:47], v[228:231], v[208:211], v[32:47]
    ds_read_b128 v[168:171], v4 offset:0
    ds_read_b64_tr_b16 v[188:189], v6 offset:24576
    v_mfma_f32_32x32x16_bf16 v[64:79], v[228:231], v[212:215], v[64:79]
    ds_read_b64_tr_b16 v[190:191], v6 offset:26624
    ds_read_b128 v[172:175], v4 offset:4096
    v_mfma_f32_32x32x16_bf16 v[48:63], v[224:227], v[212:215], v[48:63]
    s_mul_i32 s8, s91, 14336
    s_add_u32 s8, s8, s85
    s_add_u32 m0, s14, 100352
    s_add_u32 s7, s8, 7168
    ds_read_b128 v[176:179], v4 offset:8192
    ds_read_b128 v[180:183], v4 offset:12288
    v_mfma_f32_32x32x16_bf16 v[80:95], v[224:227], v[216:219], v[80:95]
    buffer_load_dwordx4 v158, s[56:59], s8 offen lds
    s_add_u32 m0, s14, 101376
    s_add_u32 s91, s91, 1
    s_waitcnt vmcnt(3)
    v_min3_u32 v154, v201, v203, v248
    v_max3_u32 v155, v201, v203, v248
    v_min3_u32 v154, v205, v207, v154
    v_mfma_f32_32x32x16_bf16 v[96:111], v[228:231], v[216:219], v[96:111]
    v_max3_u32 v155, v205, v207, v155
    v_min3_u32 v154, v233, v235, v154
    v_max3_u32 v155, v233, v235, v155
    v_min3_u32 v154, v237, v239, v154
    v_mfma_f32_32x32x16_bf16 v[128:143], v[228:231], v[220:223], v[128:143]
    buffer_load_dwordx4 v158, s[56:59], s7 offen lds
    s_cmp_eq_u32 s91, 28
    s_cselect_b32 s91, 0, s91
    v_max3_u32 v155, v237, v239, v155
    v_cmp_ne_u32 vcc, v154, v155
    s_cbranch_vccnz L_csr
L_cs_ok:
    v_mfma_f32_32x32x16_bf16 v[112:127], v[224:227], v[220:223], v[112:127]
    s_waitcnt lgkmcnt(0)
    ds_write_b32 v254, v255 offset:65328
    v_mfma_f32_32x32x16_bf16 v[16:31], v[184:187], v[168:171], v[16:31]
    v_add_f32 v200, v200, v202
    v_add_f32 v204, v204, v206
    v_add_f32 v232, v232, v234
    v_add_f32 v236, v236, v238
    v_add_f32 v200, v200, v204
    v_add_f32 v232, v232, v236
    v_mfma_f32_32x32x16_bf16 v[32:47], v[188:191], v[168:171], v[32:47]
    v_add_f32 v13, v200, v232
    v_cvt_pk_bf16_f32 v14, v13, v13
    v_and_b32 v14, 0xffff0000, v14
    v_sub_f32 v13, v13, v14
    v_cvt_pk_bf16_f32 v160, v14, v13
    s_nop 1
    v_mfma_f32_32x32x16_bf16 v[48:63], v[184:187], v[172:175], v[48:63]
    v_permlane32_swap_b32 v160, v164
    v_mfma_f32_32x32x16_bf16 v[64:79], v[188:191], v[172:175], v[64:79]
    s_mul_i32 s8, s91, 14336
    s_add_u32 s8, s8, s85
    s_add_u32 m0, s14, 102400
    s_add_u32 s7, s8, 7168
    v_mfma_f32_32x32x16_bf16 v[80:95], v[184:187], v[176:179], v[80:95]
    buffer_load_dwordx4 v158, s[56:59], s8 offen lds
    s_add_u32 m0, s14, 103424
    s_add_u32 s91, s91, 1
    v_mfma_f32_32x32x16_bf16 v[96:111], v[188:191], v[176:179], v[96:111]
    v_mfma_f32_32x32x16_bf16 v[112:127], v[184:187], v[180:183], v[112:127]
    buffer_load_dwordx4 v158, s[56:59], s7 offen lds
    s_cmp_eq_u32 s91, 28
    s_cselect_b32 s91, 0, s91
    v_mfma_f32_32x32x16_bf16 v[128:143], v[188:191], v[180:183], v[128:143]
    s_nop 0
    v_mfma_f32_32x32x16_bf16 v[16:31], v[160:163], v[144:147], v[16:31]
    v_xor_b32 v2, 0x2000, v253
    v_xor_b32 v3, 0x4000, v253
    v_xor_b32 v4, 0x6000, v253
    v_add_u32 v5, -32768, v253
    v_lshrrev_b32 v6, 7, v249
    v_mov_b32 v14, v158
    v_mfma_f32_32x32x16_bf16 v[32:47], v[164:167], v[144:147], v[32:47]
    v_mov_b32 v15, v159
    s_nop 3
    v_mfma_f32_32x32x16_bf16 v[48:63], v[160:163], v[146:149], v[48:63]
    v_mul_f32 v16, v16, v24
    v_mul_f32 v17, v17, v25
    v_mul_f32 v18, v18, v26
    v_mul_f32 v19, v19, v27
    v_mul_f32 v20, v20, v28
    v_mul_f32 v21, v21, v29
    v_mul_f32 v22, v22, v30
    v_mfma_f32_32x32x16_bf16 v[64:79], v[164:167], v[146:149], v[64:79]
    v_mul_f32 v23, v23, v31
    v_cvt_pk_bf16_f32 v24, v16, v17
    v_cvt_pk_bf16_f32 v25, v18, v19
    v_cvt_pk_bf16_f32 v26, v20, v21
    v_cvt_pk_bf16_f32 v27, v22, v23
    buffer_store_dwordx4 v[24:27], v8, s[68:71], s81 offen offset:0 sc1
    v_mul_f32 v32, v32, v40
    v_mfma_f32_32x32x16_bf16 v[80:95], v[160:163], v[148:151], v[80:95]
    v_mul_f32 v33, v33, v41
    v_mul_f32 v34, v34, v42
    v_mul_f32 v35, v35, v43
    v_mul_f32 v36, v36, v44
    v_mul_f32 v37, v37, v45
    v_mul_f32 v38, v38, v46
    v_mul_f32 v39, v39, v47
    v_mfma_f32_32x32x16_bf16 v[96:111], v[164:167], v[148:151], v[96:111]
    v_cvt_pk_bf16_f32 v40, v32, v33
    v_cvt_pk_bf16_f32 v41, v34, v35
    v_cvt_pk_bf16_f32 v42, v36, v37
    v_cvt_pk_bf16_f32 v43, v38, v39
    buffer_store_dwordx4 v[40:43], v8, s[68:71], s81 offen offset:1024 sc1
    v_mul_f32 v48, v48, v56
    v_mul_f32 v49, v49, v57
    v_mfma_f32_32x32x16_bf16 v[112:127], v[160:163], v[150:153], v[112:127]
    v_mul_f32 v50, v50, v58
    v_mul_f32 v51, v51, v59
    v_mul_f32 v52, v52, v60
    v_mul_f32 v53, v53, v61
    v_mul_f32 v54, v54, v62
    v_mul_f32 v55, v55, v63
    v_cvt_pk_bf16_f32 v56, v48, v49
    v_mfma_f32_32x32x16_bf16 v[128:143], v[164:167], v[150:153], v[128:143]
    v_cvt_pk_bf16_f32 v57, v50, v51
    v_cvt_pk_bf16_f32 v58, v52, v53
    v_cvt_pk_bf16_f32 v59, v54, v55
    buffer_store_dwordx4 v[56:59], v8, s[68:71], s82 offen offset:0 sc1
    v_mul_f32 v64, v64, v72
    v_mul_f32 v65, v65, v73
    v_mul_f32 v66, v66, v74
    v_mul_f32 v67, v67, v75
    v_mul_f32 v68, v68, v76
    v_mul_f32 v69, v69, v77
    v_mul_f32 v70, v70, v78
    v_mul_f32 v71, v71, v79
    v_cvt_pk_bf16_f32 v72, v64, v65
    v_cvt_pk_bf16_f32 v73, v66, v67
    v_cvt_pk_bf16_f32 v74, v68, v69
    v_cvt_pk_bf16_f32 v75, v70, v71
    buffer_store_dwordx4 v[72:75], v8, s[68:71], s82 offen offset:1024 sc1
    v_pk_mul_f32 v[80:81], v[80:81], v[88:89]
    v_pk_mul_f32 v[82:83], v[82:83], v[90:91]
    v_pk_mul_f32 v[84:85], v[84:85], v[92:93]
    v_pk_mul_f32 v[86:87], v[86:87], v[94:95]
    v_cvt_pk_bf16_f32 v88, v80, v81
    v_cvt_pk_bf16_f32 v89, v82, v83
    v_cvt_pk_bf16_f32 v90, v84, v85
    v_cvt_pk_bf16_f32 v91, v86, v87
    buffer_store_dwordx4 v[88:91], v8, s[68:71], s83 offen offset:0 sc1
    v_pk_mul_f32 v[96:97], v[96:97], v[104:105]
    v_pk_mul_f32 v[98:99], v[98:99], v[106:107]
    v_pk_mul_f32 v[100:101], v[100:101], v[108:109]
    v_pk_mul_f32 v[102:103], v[102:103], v[110:111]
    v_cvt_pk_bf16_f32 v104, v96, v97
    v_cvt_pk_bf16_f32 v105, v98, v99
    v_cvt_pk_bf16_f32 v106, v100, v101
    v_cvt_pk_bf16_f32 v107, v102, v103
    buffer_store_dwordx4 v[104:107], v8, s[68:71], s83 offen offset:1024 sc1
    v_pk_mul_f32 v[112:113], v[112:113], v[120:121]
    v_pk_mul_f32 v[114:115], v[114:115], v[122:123]
    v_pk_mul_f32 v[116:117], v[116:117], v[124:125]
    v_pk_mul_f32 v[118:119], v[118:119], v[126:127]
    v_cvt_pk_bf16_f32 v120, v112, v113
    v_cvt_pk_bf16_f32 v121, v114, v115
    v_cvt_pk_bf16_f32 v122, v116, v117
    v_cvt_pk_bf16_f32 v123, v118, v119
    buffer_store_dwordx4 v[120:123], v8, s[68:71], s84 offen offset:0 sc1
    v_pk_mul_f32 v[128:129], v[128:129], v[136:137]
    v_pk_mul_f32 v[130:131], v[130:131], v[138:139]
    v_pk_mul_f32 v[132:133], v[132:133], v[140:141]
    v_pk_mul_f32 v[134:135], v[134:135], v[142:143]
    v_cvt_pk_bf16_f32 v136, v128, v129
    v_cvt_pk_bf16_f32 v137, v130, v131
    v_cvt_pk_bf16_f32 v138, v132, v133
    v_cvt_pk_bf16_f32 v139, v134, v135
    buffer_store_dwordx4 v[136:139], v8, s[68:71], s84 offen offset:1024 sc1
    s_lshl4_add_u32 s9, s4, s5
    s_lshl_b32 s9, s9, 9
    s_add_u32 s9, s9, 9764864
    v_mov_b32 v10, 0
    s_mov_b64 exec, 1
    s_waitcnt vmcnt(0)
    ds_add_rtn_u32 v9, v10, v255 offset:65344
    s_waitcnt lgkmcnt(0)
    v_cmp_eq_u32 vcc, 3, v9
    s_cbranch_vccz L_nofl
    buffer_store_dword v248, off, s[68:71], s9 sc1
L_nofl:
    s_mov_b64 exec, -1
    s_mov_b32 s15, 200000
L_fd:
    ds_read_b32 v9, v6 offset:65328
    s_waitcnt lgkmcnt(0)
    v_cmp_gt_u32 vcc, 1, v9
    s_cbranch_vccz L_fd_ok
    s_sub_u32 s15, s15, 1
    s_cbranch_scc0 L_fd
L_fd_ok:
    s_setprio 0
    s_mul_i32 s8, s91, 14336
    s_add_u32 s8, s8, s85
    s_add_u32 m0, s14, 104448
    s_add_u32 s7, s8, 7168
    buffer_load_dwordx4 v14, s[56:59], s8 offen lds
    s_add_u32 m0, s14, 105472
    s_add_u32 s91, s91, 1
    buffer_load_dwordx4 v14, s[56:59], s7 offen lds
    s_cmp_eq_u32 s91, 28
    s_cselect_b32 s91, 0, s91
    s_mul_i32 s8, s91, 14336
    s_add_u32 s8, s8, s85
    s_add_u32 m0, s14, 131072
    s_add_u32 s7, s8, 7168
    buffer_load_dwordx4 v14, s[56:59], s8 offen lds
    s_add_u32 m0, s14, 132096
    s_add_u32 s91, s91, 1
    buffer_load_dwordx4 v14, s[56:59], s7 offen lds
    s_cmp_eq_u32 s91, 28
    s_cselect_b32 s91, 0, s91
    s_mul_i32 s8, s91, 14336
    s_add_u32 s8, s8, s85
    s_add_u32 m0, s14, 133120
    s_add_u32 s7, s8, 7168
    buffer_load_dwordx4 v14, s[56:59], s8 offen lds
    s_add_u32 m0, s14, 134144
    s_add_u32 s91, s91, 1
    buffer_load_dwordx4 v14, s[56:59], s7 offen lds
    s_cmp_eq_u32 s91, 28
    s_cselect_b32 s91, 0, s91
    s_mul_i32 s8, s91, 14336
    s_add_u32 s8, s8, s85
    s_add_u32 m0, s14, 135168
    s_add_u32 s7, s8, 7168
    buffer_load_dwordx4 v14, s[56:59], s8 offen lds
    s_add_u32 m0, s14, 136192
    s_add_u32 s91, s91, 1
    buffer_load_dwordx4 v14, s[56:59], s7 offen lds
    s_cmp_eq_u32 s91, 28
    s_cselect_b32 s91, 0, s91
    s_mul_i32 s8, s91, 14336
    s_add_u32 s8, s8, s85
    s_add_u32 m0, s14, 137216
    s_add_u32 s7, s8, 7168
    buffer_load_dwordx4 v14, s[56:59], s8 offen lds
    s_add_u32 m0, s14, 138240
    s_add_u32 s91, s91, 1
    buffer_load_dwordx4 v14, s[56:59], s7 offen lds
    s_cmp_eq_u32 s91, 28
    s_cselect_b32 s91, 0, s91
    s_mul_i32 s8, s91, 14336
    s_add_u32 s8, s8, s85
    s_add_u32 m0, s14, 65536
    s_add_u32 s7, s8, 7168
    buffer_load_dwordx4 v14, s[56:59], s8 offen lds
    s_add_u32 m0, s14, 66560
    s_add_u32 s91, s91, 1
    buffer_load_dwordx4 v14, s[56:59], s7 offen lds
    s_cmp_eq_u32 s91, 28
    s_cselect_b32 s91, 0, s91
    s_mul_i32 s8, s91, 14336
    s_add_u32 s8, s8, s85
    s_add_u32 m0, s14, 67584
    s_add_u32 s7, s8, 7168
    buffer_load_dwordx4 v14, s[56:59], s8 offen lds
    s_add_u32 m0, s14, 68608
    s_add_u32 s91, s91, 1
    buffer_load_dwordx4 v14, s[56:59], s7 offen lds
    s_cmp_eq_u32 s91, 28
    s_cselect_b32 s91, 0, s91
    s_mul_i32 s8, s91, 14336
    s_add_u32 s8, s8, s85
    s_add_u32 m0, s14, 69632
    s_add_u32 s7, s8, 7168
    buffer_load_dwordx4 v14, s[56:59], s8 offen lds
    s_add_u32 m0, s14, 70656
    s_add_u32 s91, s91, 1
    buffer_load_dwordx4 v14, s[56:59], s7 offen lds
    s_cmp_eq_u32 s91, 28
    s_cselect_b32 s91, 0, s91
    s_mul_i32 s8, s91, 14336
    s_add_u32 s8, s8, s85
    s_add_u32 m0, s14, 71680
    s_add_u32 s7, s8, 7168
    buffer_load_dwordx4 v14, s[56:59], s8 offen lds
    s_add_u32 m0, s14, 72704
    s_add_u32 s91, s91, 1
    buffer_load_dwordx4 v14, s[56:59], s7 offen lds
    s_cmp_eq_u32 s91, 28
    s_cselect_b32 s91, 0, s91
    ds_read_b64_tr_b16 v[208:209], v192 offset:32768
    ds_read_b64_tr_b16 v[210:211], v192 offset:33792
    ds_read_b64_tr_b16 v[212:213], v193 offset:32768
    ds_read_b64_tr_b16 v[214:215], v193 offset:33792
    ds_read_b64_tr_b16 v[216:217], v192 offset:34816
    ds_read_b64_tr_b16 v[218:219], v192 offset:35840
    ds_read_b64_tr_b16 v[220:221], v193 offset:34816
    ds_read_b64_tr_b16 v[222:223], v193 offset:35840
    ds_read_b64_tr_b16 v[80:81], v192 offset:36864
    ds_read_b64_tr_b16 v[82:83], v192 offset:37888
    ds_read_b64_tr_b16 v[84:85], v193 offset:36864
    ds_read_b64_tr_b16 v[86:87], v193 offset:37888
    s_waitcnt vmcnt(16)
    ds_read_b64_tr_b16 v[88:89], v192 offset:38912
    ds_read_b64_tr_b16 v[90:91], v192 offset:39936
    ds_read_b64_tr_b16 v[92:93], v193 offset:38912
    ds_read_b64_tr_b16 v[94:95], v193 offset:39936
    s_waitcnt vmcnt(14)
    ds_read_b64_tr_b16 v[200:201], v194 offset:0
    ds_read_b64_tr_b16 v[202:203], v194 offset:1024
    ds_read_b64_tr_b16 v[204:205], v195 offset:0
    ds_read_b64_tr_b16 v[206:207], v195 offset:1024
    s_waitcnt vmcnt(12)
    ds_read_b64_tr_b16 v[160:161], v194 offset:2048
    ds_read_b64_tr_b16 v[162:163], v194 offset:3072
    ds_read_b64_tr_b16 v[164:165], v195 offset:2048
    ds_read_b64_tr_b16 v[166:167], v195 offset:3072
    s_waitcnt vmcnt(10)
    ds_read_b64_tr_b16 v[168:169], v194 offset:4096
    ds_read_b64_tr_b16 v[170:171], v194 offset:5120
    ds_read_b64_tr_b16 v[172:173], v195 offset:4096
    ds_read_b64_tr_b16 v[174:175], v195 offset:5120
    s_waitcnt lgkmcnt(15)
    s_mul_i32 s8, s91, 14336
    s_add_u32 s8, s8, s85
    s_add_u32 m0, s14, 98304
    s_add_u32 s7, s8, 7168
    buffer_load_dwordx4 v14, s[56:59], s8 offen lds
    s_add_u32 m0, s14, 99328
    s_add_u32 s91, s91, 1
    buffer_load_dwordx4 v14, s[56:59], s7 offen lds
    s_cmp_eq_u32 s91, 28
    s_cselect_b32 s91, 0, s91
    s_waitcnt lgkmcnt(15)
    s_mul_i32 s8, s91, 14336
    s_add_u32 s8, s8, s85
    s_add_u32 m0, s14, 100352
    s_add_u32 s7, s8, 7168
    buffer_load_dwordx4 v14, s[56:59], s8 offen lds
    s_add_u32 m0, s14, 101376
    s_add_u32 s91, s91, 1
    buffer_load_dwordx4 v14, s[56:59], s7 offen lds
    s_cmp_eq_u32 s91, 28
    s_cselect_b32 s91, 0, s91
    s_waitcnt lgkmcnt(15)
    s_mul_i32 s8, s91, 14336
    s_add_u32 s8, s8, s85
    s_add_u32 m0, s14, 102400
    s_add_u32 s7, s8, 7168
    buffer_load_dwordx4 v14, s[56:59], s8 offen lds
    s_add_u32 m0, s14, 103424
    s_add_u32 s91, s91, 1
    buffer_load_dwordx4 v14, s[56:59], s7 offen lds
    s_cmp_eq_u32 s91, 28
    s_cselect_b32 s91, 0, s91
    s_waitcnt lgkmcnt(12)
    s_mul_i32 s8, s91, 14336
    s_add_u32 s8, s8, s85
    s_add_u32 m0, s14, 104448
    s_add_u32 s7, s8, 7168
    buffer_load_dwordx4 v14, s[56:59], s8 offen lds
    s_add_u32 m0, s14, 105472
    s_add_u32 s91, s91, 1
    buffer_load_dwordx4 v14, s[56:59], s7 offen lds
    s_cmp_eq_u32 s91, 28
    s_cselect_b32 s91, 0, s91
    s_waitcnt lgkmcnt(8)
    s_mul_i32 s8, s91, 14336
    s_add_u32 s8, s8, s85
    s_add_u32 m0, s14, 131072
    s_add_u32 s7, s8, 7168
    buffer_load_dwordx4 v14, s[56:59], s8 offen lds
    s_add_u32 m0, s14, 132096
    s_add_u32 s91, s91, 1
    buffer_load_dwordx4 v14, s[56:59], s7 offen lds
    s_cmp_eq_u32 s91, 28
    s_cselect_b32 s91, 0, s91
    s_waitcnt lgkmcnt(4)
    s_mul_i32 s8, s91, 14336
    s_add_u32 s8, s8, s85
    s_add_u32 m0, s14, 133120
    s_add_u32 s7, s8, 7168
    buffer_load_dwordx4 v14, s[56:59], s8 offen lds
    s_add_u32 m0, s14, 134144
    s_add_u32 s91, s91, 1
    buffer_load_dwordx4 v14, s[56:59], s7 offen lds
    s_cmp_eq_u32 s91, 28
    s_cselect_b32 s91, 0, s91
    s_waitcnt lgkmcnt(0)
    s_mul_i32 s8, s91, 14336
    s_add_u32 s8, s8, s85
    s_add_u32 m0, s14, 135168
    s_add_u32 s7, s8, 7168
    buffer_load_dwordx4 v14, s[56:59], s8 offen lds
    s_add_u32 m0, s14, 136192
    s_add_u32 s91, s91, 1
    buffer_load_dwordx4 v14, s[56:59], s7 offen lds
    s_cmp_eq_u32 s91, 28
    s_cselect_b32 s91, 0, s91
    s_mul_i32 s8, s23, 7
    s_lshr_b32 s8, s8, 1
    s_lshl4_add_u32 s8, s22, s8
    s_lshl_b32 s8, s8, 9
    s_add_u32 s8, s8, 9764864
L_gmain:
    s_movk_i32 s15, 300
    s_mov_b32 s18, s6
    s_mov_b32 s19, s6
L_f1s:
    s_buffer_load_dword s72, s[68:71], s8 offset:0 glc
    s_buffer_load_dword s73, s[68:71], s8 offset:512 glc
    s_buffer_load_dword s74, s[68:71], s8 offset:1024 glc
    s_buffer_load_dword s75, s[68:71], s8 offset:1536 glc
    s_waitcnt lgkmcnt(0)
    s_xor_b64 s[72:73], s[72:73], s[18:19]
    s_xor_b64 s[74:75], s[74:75], s[18:19]
    s_or_b64 s[72:73], s[72:73], s[74:75]
    s_cbranch_scc0 L_f1ok
    s_sleep 1
    s_sub_u32 s15, s15, 1
    s_cbranch_scc0 L_f1s
    s_mov_b32 s15, 200000
L_f1poll:
    buffer_load_dword v10, v249, s[68:71], s8 offen sc1
    s_waitcnt vmcnt(0)
    s_setprio 3
    v_cmp_ne_u32 vcc, s6, v10
    s_setprio 0
    s_cbranch_vccz L_f1ok
    s_sleep 2
    s_sub_u32 s15, s15, 1
    s_cbranch_scc0 L_f1poll
L_f1ok:
    s_lshl_b32 s9, s92, 10
    s_add_u32 s92, s92, 1
    buffer_load_dwordx4 v[176:179], v196, s[68:71], s9 offen sc1
    buffer_load_dwordx4 v[180:183], v197, s[68:71], s9 offen sc1
    s_cmp_eq_u32 s92, 28
    s_cselect_b32 s92, 0, s92
    s_lshl_b32 s9, s92, 10
    s_add_u32 s92, s92, 1
    buffer_load_dwordx4 v[184:187], v196, s[68:71], s9 offen sc1
    buffer_load_dwordx4 v[188:191], v197, s[68:71], s9 offen sc1
    s_cmp_eq_u32 s92, 28
    s_cselect_b32 s92, 0, s92
    s_lshl_b32 s9, s92, 10
    s_add_u32 s92, s92, 1
    buffer_load_dwordx4 v[224:227], v196, s[68:71], s9 offen sc1
    buffer_load_dwordx4 v[228:231], v197, s[68:71], s9 offen sc1
    s_cmp_eq_u32 s92, 28
    s_cselect_b32 s92, 0, s92
    s_lshl_b32 s9, s92, 10
    s_add_u32 s92, s92, 1
    buffer_load_dwordx4 v[232:235], v196, s[68:71], s9 offen sc1
    buffer_load_dwordx4 v[236:239], v197, s[68:71], s9 offen sc1
    s_cmp_eq_u32 s92, 28
    s_cselect_b32 s92, 0, s92
    s_lshl_b32 s7, s80, 9
    s_add_u32 s7, s7, 9732096
    buffer_load_dword v198, v250, s[68:71], s7 offen offset:4 sc1
    s_add_u32 s7, s21, 0
    s_and_b32 s7, s7, 3
    s_lshl_b32 s7, s7, 11
    s_add_u32 s96, s7, 7340032
    s_add_u32 s7, s21, 1
    s_and_b32 s7, s7, 3
    s_lshl_b32 s7, s7, 11
    s_add_u32 s97, s7, 7340032
    s_add_u32 s7, s21, 2
    s_and_b32 s7, s7, 3
    s_lshl_b32 s7, s7, 11
    s_add_u32 s98, s7, 7340032
    s_add_u32 s7, s21, 3
    s_and_b32 s7, s7, 3
    s_lshl_b32 s7, s7, 11
    s_add_u32 s99, s7, 7340032
    s_and_b32 s81, s6, 0xffff
    s_waitcnt vmcnt(7) lgkmcnt(15)
    v_mfma_f32_32x32x16_bf16 v[16:31], v[208:211], v[176:179], 0
    ds_read_b64_tr_b16 v[96:97], v194 offset:6144
    ds_read_b64_tr_b16 v[98:99], v194 offset:7168
    ds_read_b64_tr_b16 v[100:101], v195 offset:6144
    ds_read_b64_tr_b16 v[102:103], v195 offset:7168
    v_mfma_f32_32x32x16_bf16 v[32:47], v[212:215], v[176:179], 0
    s_lshl_b32 s9, s92, 10
    s_add_u32 s92, s92, 1
    v_mfma_f32_32x32x16_bf16 v[64:79], v[212:215], v[180:183], 0
    buffer_load_dwordx4 v[104:107], v196, s[68:71], s9 offen sc1
    buffer_load_dwordx4 v[108:111], v197, s[68:71], s9 offen sc1
    s_cmp_eq_u32 s92, 28
    s_cselect_b32 s92, 0, s92
    v_mfma_f32_32x32x16_bf16 v[48:63], v[208:211], v[180:183], 0
    buffer_load_dwordx4 v[240:243], v199, s[40:43], s78 offen offset:0
    buffer_load_dwordx4 v[244:247], v199, s[40:43], s78 offen offset:32
    s_waitcnt vmcnt(9) lgkmcnt(0)
    v_mfma_f32_32x32x16_bf16 v[16:31], v[216:219], v[184:187], v[16:31]
    ds_read_b64_tr_b16 v[112:113], v192 offset:0
    ds_read_b64_tr_b16 v[114:115], v192 offset:1024
    ds_read_b64_tr_b16 v[116:117], v193 offset:0
    ds_read_b64_tr_b16 v[118:119], v193 offset:1024
    s_lshl_b32 s9, s92, 10
    v_mfma_f32_32x32x16_bf16 v[32:47], v[220:223], v[184:187], v[32:47]
    s_add_u32 s92, s92, 1
    buffer_load_dwordx4 v[120:123], v196, s[68:71], s9 offen sc1
    buffer_load_dwordx4 v[124:127], v197, s[68:71], s9 offen sc1
    s_cmp_eq_u32 s92, 28
    s_cselect_b32 s92, 0, s92
    v_mfma_f32_32x32x16_bf16 v[64:79], v[220:223], v[188:191], v[64:79]
    s_mul_i32 s8, s91, 14336
    s_add_u32 s8, s8, s85
    s_add_u32 m0, s14, 137216
    s_add_u32 s7, s8, 7168
    buffer_load_dwordx4 v14, s[56:59], s8 offen lds
    s_add_u32 m0, s14, 138240
    v_mfma_f32_32x32x16_bf16 v[48:63], v[216:219], v[188:191], v[48:63]
    s_add_u32 s91, s91, 1
    buffer_load_dwordx4 v14, s[56:59], s7 offen lds
    s_cmp_eq_u32 s91, 28
    s_cselect_b32 s91, 0, s91
    s_waitcnt vmcnt(11) lgkmcnt(0)
    v_mfma_f32_32x32x16_bf16 v[16:31], v[80:83], v[224:227], v[16:31]
    ds_read_b64_tr_b16 v[128:129], v192 offset:2048
    ds_read_b64_tr_b16 v[130:131], v192 offset:3072
    ds_read_b64_tr_b16 v[132:133], v193 offset:2048
    ds_read_b64_tr_b16 v[134:135], v193 offset:3072
    s_lshl_b32 s9, s92, 10
    v_mfma_f32_32x32x16_bf16 v[32:47], v[84:87], v[224:227], v[32:47]
    s_add_u32 s92, s92, 1
    buffer_load_dwordx4 v[136:139], v196, s[68:71], s9 offen sc1
    buffer_load_dwordx4 v[140:143], v197, s[68:71], s9 offen sc1
    s_cmp_eq_u32 s92, 28
    s_cselect_b32 s92, 0, s92
    v_mfma_f32_32x32x16_bf16 v[64:79], v[84:87], v[228:231], v[64:79]
    s_mul_i32 s8, s91, 14336
    s_add_u32 s8, s8, s85
    s_add_u32 m0, s14, 65536
    s_add_u32 s7, s8, 7168
    buffer_load_dwordx4 v14, s[56:59], s8 offen lds
    s_add_u32 m0, s14, 66560
    v_mfma_f32_32x32x16_bf16 v[48:63], v[80:83], v[228:231], v[48:63]
    s_add_u32 s91, s91, 1
    buffer_load_dwordx4 v14, s[56:59], s7 offen lds
    s_cmp_eq_u32 s91, 28
    s_cselect_b32 s91, 0, s91
    s_waitcnt vmcnt(13) lgkmcnt(0)
    v_mfma_f32_32x32x16_bf16 v[16:31], v[88:91], v[232:235], v[16:31]
    ds_read_b64_tr_b16 v[144:145], v192 offset:4096
    ds_read_b64_tr_b16 v[146:147], v192 offset:5120
    ds_read_b64_tr_b16 v[148:149], v193 offset:4096
    ds_read_b64_tr_b16 v[150:151], v193 offset:5120
    s_lshl_b32 s9, s92, 10
    v_mfma_f32_32x32x16_bf16 v[32:47], v[92:95], v[232:235], v[32:47]
    s_add_u32 s92, s92, 1
    buffer_load_dwordx4 v[152:155], v196, s[68:71], s9 offen sc1
    buffer_load_dwordx4 v[156:159], v197, s[68:71], s9 offen sc1
    s_cmp_eq_u32 s92, 28
    s_cselect_b32 s92, 0, s92
    v_mfma_f32_32x32x16_bf16 v[64:79], v[92:95], v[236:239], v[64:79]
    s_mul_i32 s8, s91, 14336
    s_add_u32 s8, s8, s85
    s_add_u32 m0, s14, 67584
    s_add_u32 s7, s8, 7168
    buffer_load_dwordx4 v14, s[56:59], s8 offen lds
    s_add_u32 m0, s14, 68608
    v_mfma_f32_32x32x16_bf16 v[48:63], v[88:91], v[236:239], v[48:63]
    s_add_u32 s91, s91, 1
    buffer_load_dwordx4 v14, s[56:59], s7 offen lds
    s_cmp_eq_u32 s91, 28
    s_cselect_b32 s91, 0, s91
    s_waitcnt vmcnt(14) lgkmcnt(0)
    v_mfma_f32_32x32x16_bf16 v[16:31], v[200:203], v[104:107], v[16:31]
    ds_read_b64_tr_b16 v[208:209], v192 offset:6144
    ds_read_b64_tr_b16 v[210:211], v192 offset:7168
    ds_read_b64_tr_b16 v[212:213], v193 offset:6144
    ds_read_b64_tr_b16 v[214:215], v193 offset:7168
    s_lshl_b32 s9, s92, 10
    v_mfma_f32_32x32x16_bf16 v[32:47], v[204:207], v[104:107], v[32:47]
    s_add_u32 s92, s92, 1
    buffer_load_dwordx4 v[176:179], v196, s[68:71], s9 offen sc1
    buffer_load_dwordx4 v[180:183], v197, s[68:71], s9 offen sc1
    s_cmp_eq_u32 s92, 28
    s_cselect_b32 s92, 0, s92
    v_mfma_f32_32x32x16_bf16 v[64:79], v[204:207], v[108:111], v[64:79]
    s_mul_i32 s8, s91, 14336
    s_add_u32 s8, s8, s85
    s_add_u32 m0, s14, 69632
    s_add_u32 s7, s8, 7168
    buffer_load_dwordx4 v14, s[56:59], s8 offen lds
    s_add_u32 m0, s14, 70656
    v_mfma_f32_32x32x16_bf16 v[48:63], v[200:203], v[108:111], v[48:63]
    s_add_u32 s91, s91, 1
    buffer_load_dwordx4 v14, s[56:59], s7 offen lds
    s_cmp_eq_u32 s91, 28
    s_cselect_b32 s91, 0, s91
    s_waitcnt vmcnt(14) lgkmcnt(0)
    v_mfma_f32_32x32x16_bf16 v[16:31], v[160:163], v[120:123], v[16:31]
    ds_read_b64_tr_b16 v[216:217], v192 offset:32768
    ds_read_b64_tr_b16 v[218:219], v192 offset:33792
    ds_read_b64_tr_b16 v[220:221], v193 offset:32768
    ds_read_b64_tr_b16 v[222:223], v193 offset:33792
    s_lshl_b32 s9, s92, 10
    v_mfma_f32_32x32x16_bf16 v[32:47], v[164:167], v[120:123], v[32:47]
    s_add_u32 s92, s92, 1
    buffer_load_dwordx4 v[184:187], v196, s[68:71], s9 offen sc1
    buffer_load_dwordx4 v[188:191], v197, s[68:71], s9 offen sc1
    s_cmp_eq_u32 s92, 28
    s_cselect_b32 s92, 0, s92
    v_mfma_f32_32x32x16_bf16 v[64:79], v[164:167], v[124:127], v[64:79]
    s_mul_i32 s8, s91, 14336
    s_add_u32 s8, s8, s85
    s_add_u32 m0, s14, 71680
    s_add_u32 s7, s8, 7168
    buffer_load_dwordx4 v14, s[56:59], s8 offen lds
    s_add_u32 m0, s14, 72704
    v_mfma_f32_32x32x16_bf16 v[48:63], v[160:163], v[124:127], v[48:63]
    s_add_u32 s91, s91, 1
    buffer_load_dwordx4 v14, s[56:59], s7 offen lds
    s_cmp_eq_u32 s91, 28
    s_cselect_b32 s91, 0, s91
    s_waitcnt vmcnt(14) lgkmcnt(0)
    v_mfma_f32_32x32x16_bf16 v[16:31], v[168:171], v[136:139], v[16:31]
    ds_read_b64_tr_b16 v[80:81], v192 offset:34816
    ds_read_b64_tr_b16 v[82:83], v192 offset:35840
    ds_read_b64_tr_b16 v[84:85], v193 offset:34816
    ds_read_b64_tr_b16 v[86:87], v193 offset:35840
    s_lshl_b32 s9, s92, 10
    v_mfma_f32_32x32x16_bf16 v[32:47], v[172:175], v[136:139], v[32:47]
    s_add_u32 s92, s92, 1
    buffer_load_dwordx4 v[224:227], v196, s[68:71], s9 offen sc1
    buffer_load_dwordx4 v[228:231], v197, s[68:71], s9 offen sc1
    s_cmp_eq_u32 s92, 28
    s_cselect_b32 s92, 0, s92
    v_mfma_f32_32x32x16_bf16 v[64:79], v[172:175], v[140:143], v[64:79]
    s_mul_i32 s8, s91, 14336
    s_add_u32 s8, s8, s85
    s_add_u32 m0, s14, 98304
    s_add_u32 s7, s8, 7168
    buffer_load_dwordx4 v14, s[56:59], s8 offen lds
    s_add_u32 m0, s14, 99328
    v_mfma_f32_32x32x16_bf16 v[48:63], v[168:171], v[140:143], v[48:63]
    s_add_u32 s91, s91, 1
    buffer_load_dwordx4 v14, s[56:59], s7 offen lds
    s_cmp_eq_u32 s91, 28
    s_cselect_b32 s91, 0, s91
    s_waitcnt vmcnt(14) lgkmcnt(0)
    v_mfma_f32_32x32x16_bf16 v[16:31], v[96:99], v[152:155], v[16:31]
    ds_read_b64_tr_b16 v[88:89], v192 offset:36864
    ds_read_b64_tr_b16 v[90:91], v192 offset:37888
    ds_read_b64_tr_b16 v[92:93], v193 offset:36864
    ds_read_b64_tr_b16 v[94:95], v193 offset:37888
    s_lshl_b32 s9, s92, 10
    v_mfma_f32_32x32x16_bf16 v[32:47], v[100:103], v[152:155], v[32:47]
    s_add_u32 s92, s92, 1
    buffer_load_dwordx4 v[232:235], v196, s[68:71], s9 offen sc1
    buffer_load_dwordx4 v[236:239], v197, s[68:71], s9 offen sc1
    s_cmp_eq_u32 s92, 28
    s_cselect_b32 s92, 0, s92
    v_mfma_f32_32x32x16_bf16 v[64:79], v[100:103], v[156:159], v[64:79]
    s_mul_i32 s8, s91, 14336
    s_add_u32 s8, s8, s85
    s_add_u32 m0, s14, 100352
    s_add_u32 s7, s8, 7168
    buffer_load_dwordx4 v14, s[56:59], s8 offen lds
    s_add_u32 m0, s14, 101376
    v_mfma_f32_32x32x16_bf16 v[48:63], v[96:99], v[156:159], v[48:63]
    s_add_u32 s91, s91, 1
    buffer_load_dwordx4 v14, s[56:59], s7 offen lds
    s_cmp_eq_u32 s91, 28
    s_cselect_b32 s91, 0, s91
    s_waitcnt vmcnt(14) lgkmcnt(0)
    v_mfma_f32_32x32x16_bf16 v[16:31], v[112:115], v[176:179], v[16:31]
    ds_read_b64_tr_b16 v[200:201], v192 offset:38912
    ds_read_b64_tr_b16 v[202:203], v192 offset:39936
    ds_read_b64_tr_b16 v[204:205], v193 offset:38912
    ds_read_b64_tr_b16 v[206:207], v193 offset:39936
    s_lshl_b32 s9, s92, 10
    v_mfma_f32_32x32x16_bf16 v[32:47], v[116:119], v[176:179], v[32:47]
    s_add_u32 s92, s92, 1
    buffer_load_dwordx4 v[104:107], v196, s[68:71], s9 offen sc1
    buffer_load_dwordx4 v[108:111], v197, s[68:71], s9 offen sc1
    s_cmp_eq_u32 s92, 28
    s_cselect_b32 s92, 0, s92
    v_mfma_f32_32x32x16_bf16 v[64:79], v[116:119], v[180:183], v[64:79]
    s_mul_i32 s8, s91, 14336
    s_add_u32 s8, s8, s85
    s_add_u32 m0, s14, 102400
    s_add_u32 s7, s8, 7168
    buffer_load_dwordx4 v14, s[56:59], s8 offen lds
    s_add_u32 m0, s14, 103424
    v_mfma_f32_32x32x16_bf16 v[48:63], v[112:115], v[180:183], v[48:63]
    s_add_u32 s91, s91, 1
    buffer_load_dwordx4 v14, s[56:59], s7 offen lds
    s_cmp_eq_u32 s91, 28
    s_cselect_b32 s91, 0, s91
    s_waitcnt vmcnt(14) lgkmcnt(0)
    v_mfma_f32_32x32x16_bf16 v[16:31], v[128:131], v[184:187], v[16:31]
    ds_read_b64_tr_b16 v[160:161], v194 offset:0
    ds_read_b64_tr_b16 v[162:163], v194 offset:1024
    ds_read_b64_tr_b16 v[164:165], v195 offset:0
    ds_read_b64_tr_b16 v[166:167], v195 offset:1024
    s_lshl_b32 s9, s92, 10
    v_mfma_f32_32x32x16_bf16 v[32:47], v[132:135], v[184:187], v[32:47]
    s_add_u32 s92, s92, 1
    buffer_load_dwordx4 v[120:123], v196, s[68:71], s9 offen sc1
    buffer_load_dwordx4 v[124:127], v197, s[68:71], s9 offen sc1
    s_cmp_eq_u32 s92, 28
    s_cselect_b32 s92, 0, s92
    v_mfma_f32_32x32x16_bf16 v[64:79], v[132:135], v[188:191], v[64:79]
    s_mul_i32 s8, s91, 14336
    s_add_u32 s8, s8, s85
    s_add_u32 m0, s14, 104448
    s_add_u32 s7, s8, 7168
    buffer_load_dwordx4 v14, s[56:59], s8 offen lds
    s_add_u32 m0, s14, 105472
    v_mfma_f32_32x32x16_bf16 v[48:63], v[128:131], v[188:191], v[48:63]
    s_add_u32 s91, s91, 1
    buffer_load_dwordx4 v14, s[56:59], s7 offen lds
    s_cmp_eq_u32 s91, 28
    s_cselect_b32 s91, 0, s91
    s_waitcnt vmcnt(14) lgkmcnt(0)
    v_mfma_f32_32x32x16_bf16 v[16:31], v[144:147], v[224:227], v[16:31]
    ds_read_b64_tr_b16 v[168:169], v194 offset:2048
    ds_read_b64_tr_b16 v[170:171], v194 offset:3072
    ds_read_b64_tr_b16 v[172:173], v195 offset:2048
    ds_read_b64_tr_b16 v[174:175], v195 offset:3072
    s_lshl_b32 s9, s92, 10
    v_mfma_f32_32x32x16_bf16 v[32:47], v[148:151], v[224:227], v[32:47]
    s_add_u32 s92, s92, 1
    buffer_load_dwordx4 v[136:139], v196, s[68:71], s9 offen sc1
    buffer_load_dwordx4 v[140:143], v197, s[68:71], s9 offen sc1
    s_cmp_eq_u32 s92, 28
    s_cselect_b32 s92, 0, s92
    v_mfma_f32_32x32x16_bf16 v[64:79], v[148:151], v[228:231], v[64:79]
    s_lshl1_add_u32 s7, s21, 0
    s_and_b32 s7, s7, 7
    s_mul_i32 s8, s7, 12544
    s_add_u32 s8, s8, s90
    s_add_u32 m0, s14, 131072
    s_add_u32 s7, s8, 7168
    v_mfma_f32_32x32x16_bf16 v[48:63], v[144:147], v[228:231], v[48:63]
    buffer_load_dwordx4 v14, s[60:63], s8 offen lds
    s_add_u32 m0, s14, 132096
    s_nop 0
    buffer_load_dwordx4 v15, s[60:63], s7 offen lds
    s_waitcnt vmcnt(14) lgkmcnt(0)
    v_mfma_f32_32x32x16_bf16 v[16:31], v[208:211], v[232:235], v[16:31]
    ds_read_b64_tr_b16 v[96:97], v194 offset:4096
    ds_read_b64_tr_b16 v[98:99], v194 offset:5120
    ds_read_b64_tr_b16 v[100:101], v195 offset:4096
    ds_read_b64_tr_b16 v[102:103], v195 offset:5120
    s_lshl_b32 s9, s92, 10
    v_mfma_f32_32x32x16_bf16 v[32:47], v[212:215], v[232:235], v[32:47]
    s_add_u32 s92, s92, 1
    buffer_load_dwordx4 v[152:155], v196, s[68:71], s9 offen sc1
    buffer_load_dwordx4 v[156:159], v197, s[68:71], s9 offen sc1
    s_cmp_eq_u32 s92, 28
    s_cselect_b32 s92, 0, s92
    v_mfma_f32_32x32x16_bf16 v[64:79], v[212:215], v[236:239], v[64:79]
    s_lshl1_add_u32 s7, s21, 1
    s_and_b32 s7, s7, 7
    s_mul_i32 s8, s7, 12544
    s_add_u32 s8, s8, s90
    s_add_u32 m0, s14, 133120
    s_add_u32 s7, s8, 7168
    v_mfma_f32_32x32x16_bf16 v[48:63], v[208:211], v[236:239], v[48:63]
    buffer_load_dwordx4 v14, s[60:63], s8 offen lds
    s_add_u32 m0, s14, 134144
    s_nop 0
    buffer_load_dwordx4 v15, s[60:63], s7 offen lds
    s_waitcnt vmcnt(14) lgkmcnt(0)
    v_mfma_f32_32x32x16_bf16 v[16:31], v[216:219], v[104:107], v[16:31]
    ds_read_b64_tr_b16 v[112:113], v194 offset:6144
    ds_read_b64_tr_b16 v[114:115], v194 offset:7168
    ds_read_b64_tr_b16 v[116:117], v195 offset:6144
    ds_read_b64_tr_b16 v[118:119], v195 offset:7168
    s_lshl_b32 s9, s92, 10
    v_mfma_f32_32x32x16_bf16 v[32:47], v[220:223], v[104:107], v[32:47]
    s_add_u32 s92, s92, 1
    buffer_load_dwordx4 v[176:179], v196, s[68:71], s9 offen sc1
    buffer_load_dwordx4 v[180:183], v197, s[68:71], s9 offen sc1
    s_cmp_eq_u32 s92, 28
    s_cselect_b32 s92, 0, s92
    v_mfma_f32_32x32x16_bf16 v[64:79], v[220:223], v[108:111], v[64:79]
    s_lshl1_add_u32 s7, s21, 2
    s_and_b32 s7, s7, 7
    s_mul_i32 s8, s7, 12544
    s_add_u32 s8, s8, s90
    s_add_u32 m0, s14, 135168
    s_add_u32 s7, s8, 7168
    v_mfma_f32_32x32x16_bf16 v[48:63], v[216:219], v[108:111], v[48:63]
    buffer_load_dwordx4 v14, s[60:63], s8 offen lds
    s_add_u32 m0, s14, 136192
    s_nop 0
    buffer_load_dwordx4 v15, s[60:63], s7 offen lds
    s_waitcnt vmcnt(14) lgkmcnt(0)
    v_mfma_f32_32x32x16_bf16 v[16:31], v[80:83], v[120:123], v[16:31]
    ds_read_b64_tr_b16 v[128:129], v192 offset:0
    ds_read_b64_tr_b16 v[130:131], v192 offset:1024
    ds_read_b64_tr_b16 v[132:133], v193 offset:0
    ds_read_b64_tr_b16 v[134:135], v193 offset:1024
    s_lshl_b32 s9, s92, 10
    v_mfma_f32_32x32x16_bf16 v[32:47], v[84:87], v[120:123], v[32:47]
    s_add_u32 s92, s92, 1
    buffer_load_dwordx4 v[184:187], v196, s[68:71], s9 offen sc1
    buffer_load_dwordx4 v[188:191], v197, s[68:71], s9 offen sc1
    s_cmp_eq_u32 s92, 28
    s_cselect_b32 s92, 0, s92
    v_mfma_f32_32x32x16_bf16 v[64:79], v[84:87], v[124:127], v[64:79]
    s_lshl1_add_u32 s7, s21, 3
    s_and_b32 s7, s7, 7
    s_mul_i32 s8, s7, 12544
    s_add_u32 s8, s8, s90
    s_add_u32 m0, s14, 137216
    s_add_u32 s7, s8, 7168
    v_mfma_f32_32x32x16_bf16 v[48:63], v[80:83], v[124:127], v[48:63]
    buffer_load_dwordx4 v14, s[60:63], s8 offen lds
    s_add_u32 m0, s14, 138240
    s_nop 0
    buffer_load_dwordx4 v15, s[60:63], s7 offen lds
    s_waitcnt vmcnt(14) lgkmcnt(0)
    v_mfma_f32_32x32x16_bf16 v[16:31], v[88:91], v[136:139], v[16:31]
    ds_read_b64_tr_b16 v[144:145], v192 offset:2048
    ds_read_b64_tr_b16 v[146:147], v192 offset:3072
    ds_read_b64_tr_b16 v[148:149], v193 offset:2048
    ds_read_b64_tr_b16 v[150:151], v193 offset:3072
    s_lshl_b32 s9, s92, 10
    v_mfma_f32_32x32x16_bf16 v[32:47], v[92:95], v[136:139], v[32:47]
    s_add_u32 s92, s92, 1
    buffer_load_dwordx4 v[224:227], v196, s[68:71], s9 offen sc1
    buffer_load_dwordx4 v[228:231], v197, s[68:71], s9 offen sc1
    s_cmp_eq_u32 s92, 28
    s_cselect_b32 s92, 0, s92
    v_mfma_f32_32x32x16_bf16 v[64:79], v[92:95], v[140:143], v[64:79]
    s_lshl1_add_u32 s7, s21, 4
    s_and_b32 s7, s7, 7
    s_mul_i32 s8, s7, 12544
    s_add_u32 s8, s8, s90
    s_add_u32 m0, s14, 65536
    s_add_u32 s7, s8, 7168
    v_mfma_f32_32x32x16_bf16 v[48:63], v[88:91], v[140:143], v[48:63]
    buffer_load_dwordx4 v14, s[60:63], s8 offen lds
    s_add_u32 m0, s14, 66560
    s_nop 0
    buffer_load_dwordx4 v15, s[60:63], s7 offen lds
    s_waitcnt vmcnt(14) lgkmcnt(0)
    v_mfma_f32_32x32x16_bf16 v[16:31], v[200:203], v[152:155], v[16:31]
    ds_read_b64_tr_b16 v[208:209], v192 offset:4096
    ds_read_b64_tr_b16 v[210:211], v192 offset:5120
    ds_read_b64_tr_b16 v[212:213], v193 offset:4096
    ds_read_b64_tr_b16 v[214:215], v193 offset:5120
    s_lshl_b32 s9, s92, 10
    v_mfma_f32_32x32x16_bf16 v[32:47], v[204:207], v[152:155], v[32:47]
    s_add_u32 s92, s92, 1
    buffer_load_dwordx4 v[232:235], v196, s[68:71], s9 offen sc1
    buffer_load_dwordx4 v[236:239], v197, s[68:71], s9 offen sc1
    s_cmp_eq_u32 s92, 28
    s_cselect_b32 s92, 0, s92
    v_mfma_f32_32x32x16_bf16 v[64:79], v[204:207], v[156:159], v[64:79]
    s_lshl1_add_u32 s7, s21, 5
    s_and_b32 s7, s7, 7
    s_mul_i32 s8, s7, 12544
    s_add_u32 s8, s8, s90
    s_add_u32 m0, s14, 67584
    s_add_u32 s7, s8, 7168
    v_mfma_f32_32x32x16_bf16 v[48:63], v[200:203], v[156:159], v[48:63]
    buffer_load_dwordx4 v14, s[60:63], s8 offen lds
    s_add_u32 m0, s14, 68608
    s_nop 0
    buffer_load_dwordx4 v15, s[60:63], s7 offen lds
    s_waitcnt vmcnt(14) lgkmcnt(0)
    v_mfma_f32_32x32x16_bf16 v[16:31], v[160:163], v[176:179], v[16:31]
    ds_read_b64_tr_b16 v[216:217], v192 offset:6144
    ds_read_b64_tr_b16 v[218:219], v192 offset:7168
    ds_read_b64_tr_b16 v[220:221], v193 offset:6144
    ds_read_b64_tr_b16 v[222:223], v193 offset:7168
    s_lshl_b32 s9, s92, 10
    v_mfma_f32_32x32x16_bf16 v[32:47], v[164:167], v[176:179], v[32:47]
    s_add_u32 s92, s92, 1
    buffer_load_dwordx4 v[104:107], v196, s[68:71], s9 offen sc1
    buffer_load_dwordx4 v[108:111], v197, s[68:71], s9 offen sc1
    s_cmp_eq_u32 s92, 28
    s_cselect_b32 s92, 0, s92
    v_mfma_f32_32x32x16_bf16 v[64:79], v[164:167], v[180:183], v[64:79]
    s_lshl1_add_u32 s7, s21, 6
    s_and_b32 s7, s7, 7
    s_mul_i32 s8, s7, 12544
    s_add_u32 s8, s8, s90
    s_add_u32 m0, s14, 69632
    s_add_u32 s7, s8, 7168
    v_mfma_f32_32x32x16_bf16 v[48:63], v[160:163], v[180:183], v[48:63]
    buffer_load_dwordx4 v14, s[60:63], s8 offen lds
    s_add_u32 m0, s14, 70656
    s_nop 0
    buffer_load_dwordx4 v15, s[60:63], s7 offen lds
    s_waitcnt lgkmcnt(0)
    s_lshl1_add_u32 s7, s21, 7
    s_and_b32 s7, s7, 7
    s_mul_i32 s8, s7, 12544
    s_add_u32 s8, s8, s90
    s_add_u32 m0, s14, 71680
    s_add_u32 s7, s8, 7168
    buffer_load_dwordx4 v14, s[60:63], s8 offen lds
    s_add_u32 m0, s14, 72704
    s_nop 0
    buffer_load_dwordx4 v15, s[60:63], s7 offen lds
    s_lshl_b32 s9, s92, 10
    s_add_u32 s92, s92, 1
    buffer_load_dwordx4 v[80:83], v196, s[68:71], s9 offen sc1
    buffer_load_dwordx4 v[84:87], v197, s[68:71], s9 offen sc1
    s_cmp_eq_u32 s92, 28
    s_cselect_b32 s92, 0, s92
    s_lshl_b32 s9, s92, 10
    s_add_u32 s92, s92, 1
    buffer_load_dwordx4 v[120:123], v196, s[68:71], s9 offen sc1
    buffer_load_dwordx4 v[124:127], v197, s[68:71], s9 offen sc1
    s_cmp_eq_u32 s92, 28
    s_cselect_b32 s92, 0, s92
    s_lshl_b32 s9, s92, 10
    s_add_u32 s92, s92, 1
    buffer_load_dwordx4 v[88:91], v196, s[68:71], s9 offen sc1
    buffer_load_dwordx4 v[92:95], v197, s[68:71], s9 offen sc1
    s_cmp_eq_u32 s92, 28
    s_cselect_b32 s92, 0, s92
    s_lshl_b32 s9, s92, 10
    s_add_u32 s92, s92, 1
    buffer_load_dwordx4 v[136:139], v196, s[68:71], s9 offen sc1
    buffer_load_dwordx4 v[140:143], v197, s[68:71], s9 offen sc1
    s_cmp_eq_u32 s92, 28
    s_cselect_b32 s92, 0, s92
    s_lshl_b32 s9, s92, 10
    s_add_u32 s92, s92, 1
    buffer_load_dwordx4 v[200:203], v196, s[68:71], s9 offen sc1
    buffer_load_dwordx4 v[204:207], v197, s[68:71], s9 offen sc1
    s_cmp_eq_u32 s92, 28
    s_cselect_b32 s92, 0, s92
    s_lshl_b32 s9, s92, 10
    s_add_u32 s92, s92, 1
    buffer_load_dwordx4 v[152:155], v196, s[68:71], s9 offen sc1
    buffer_load_dwordx4 v[156:159], v197, s[68:71], s9 offen sc1
    s_cmp_eq_u32 s92, 28
    s_cselect_b32 s92, 0, s92
    s_lshl_b32 s9, s92, 10
    s_add_u32 s92, s92, 1
    buffer_load_dwordx4 v[160:163], v196, s[68:71], s9 offen sc1
    buffer_load_dwordx4 v[164:167], v197, s[68:71], s9 offen sc1
    s_cmp_eq_u32 s92, 28
    s_cselect_b32 s92, 0, s92
    s_mov_b32 s15, 200000
L_gat0:
    ds_read_b32 v9, v6 offset:65312
    s_waitcnt lgkmcnt(0)
    v_cmp_gt_u32 vcc, 3, v9
    s_cbranch_vccz L_gat0_ok
    s_sleep 5
    s_sub_u32 s15, s15, 1
    s_cbranch_scc0 L_gat0
L_gat0_ok:
    s_mov_b32 s15, 200000
L_gate:
    ds_read_b32 v9, v6 offset:65312
    s_waitcnt lgkmcnt(0)
    v_cmp_gt_u32 vcc, 4, v9
    s_cbranch_vccz L_gate_ok
    s_sleep 1
    s_sub_u32 s15, s15, 1
    s_cbranch_scc0 L_gate
L_gate_ok:
    s_waitcnt vmcnt(30) lgkmcnt(15)
    v_mfma_f32_32x32x16_bf16 v[16:31], v[168:171], v[184:187], v[16:31]
    ds_read_b64_tr_b16 v[176:177], v192 offset:32768
    ds_read_b64_tr_b16 v[178:179], v192 offset:33792
    v_mfma_f32_32x32x16_bf16 v[32:47], v[172:175], v[184:187], v[32:47]
    ds_read_b64_tr_b16 v[180:181], v193 offset:32768
    v_mfma_f32_32x32x16_bf16 v[64:79], v[172:175], v[188:191], v[64:79]
    ds_read_b64_tr_b16 v[182:183], v193 offset:33792
    v_mfma_f32_32x32x16_bf16 v[48:63], v[168:171], v[188:191], v[48:63]
    s_waitcnt vmcnt(26) lgkmcnt(15)
    v_mfma_f32_32x32x16_bf16 v[16:31], v[96:99], v[224:227], v[16:31]
    ds_read_b64_tr_b16 v[168:169], v192 offset:34816
    ds_read_b64_tr_b16 v[170:171], v192 offset:35840
    v_mfma_f32_32x32x16_bf16 v[32:47], v[100:103], v[224:227], v[32:47]
    ds_read_b64_tr_b16 v[172:173], v193 offset:34816
    v_mfma_f32_32x32x16_bf16 v[64:79], v[100:103], v[228:231], v[64:79]
    ds_read_b64_tr_b16 v[174:175], v193 offset:35840
    v_mfma_f32_32x32x16_bf16 v[48:63], v[96:99], v[228:231], v[48:63]
    s_waitcnt vmcnt(22) lgkmcnt(15)
    v_mfma_f32_32x32x16_bf16 v[16:31], v[112:115], v[232:235], v[16:31]
    ds_read_b64_tr_b16 v[184:185], v192 offset:36864
    ds_read_b64_tr_b16 v[186:187], v192 offset:37888
    v_mfma_f32_32x32x16_bf16 v[32:47], v[116:119], v[232:235], v[32:47]
    ds_read_b64_tr_b16 v[188:189], v193 offset:36864
    v_mfma_f32_32x32x16_bf16 v[64:79], v[116:119], v[236:239], v[64:79]
    ds_read_b64_tr_b16 v[190:191], v193 offset:37888
    v_mfma_f32_32x32x16_bf16 v[48:63], v[112:115], v[236:239], v[48:63]
    s_waitcnt vmcnt(18) lgkmcnt(15)
    v_mfma_f32_32x32x16_bf16 v[16:31], v[128:131], v[104:107], v[16:31]
    ds_read_b64_tr_b16 v[96:97], v192 offset:38912
    ds_read_b64_tr_b16 v[98:99], v192 offset:39936
    v_mfma_f32_32x32x16_bf16 v[32:47], v[132:135], v[104:107], v[32:47]
    ds_read_b64_tr_b16 v[100:101], v193 offset:38912
    v_mfma_f32_32x32x16_bf16 v[64:79], v[132:135], v[108:111], v[64:79]
    ds_read_b64_tr_b16 v[102:103], v193 offset:39936
    v_mfma_f32_32x32x16_bf16 v[48:63], v[128:131], v[108:111], v[48:63]
    s_waitcnt vmcnt(12) lgkmcnt(15)
    v_mfma_f32_32x32x16_bf16 v[16:31], v[144:147], v[80:83], v[16:31]
    ds_read_b64_tr_b16 v[224:225], v194 offset:0
    ds_read_b64_tr_b16 v[226:227], v194 offset:1024
    v_mfma_f32_32x32x16_bf16 v[32:47], v[148:151], v[80:83], v[32:47]
    ds_read_b64_tr_b16 v[228:229], v195 offset:0
    v_mfma_f32_32x32x16_bf16 v[64:79], v[148:151], v[84:87], v[64:79]
    ds_read_b64_tr_b16 v[230:231], v195 offset:1024
    v_mfma_f32_32x32x16_bf16 v[48:63], v[144:147], v[84:87], v[48:63]
    s_waitcnt vmcnt(10) lgkmcnt(15)
    v_mfma_f32_32x32x16_bf16 v[16:31], v[208:211], v[120:123], v[16:31]
    ds_read_b64_tr_b16 v[232:233], v194 offset:2048
    ds_read_b64_tr_b16 v[234:235], v194 offset:3072
    ds_read_b64_tr_b16 v[236:237], v195 offset:2048
    v_mfma_f32_32x32x16_bf16 v[32:47], v[212:215], v[120:123], v[32:47]
    ds_read_b64_tr_b16 v[238:239], v195 offset:3072
    v_mfma_f32_32x32x16_bf16 v[64:79], v[212:215], v[124:127], v[64:79]
    buffer_load_dwordx4 v[112:115], v251, s[68:71], s96 offen offset:0 sc1
    v_mfma_f32_32x32x16_bf16 v[48:63], v[208:211], v[124:127], v[48:63]
    buffer_load_dwordx4 v[116:119], v252, s[68:71], s96 offen offset:0 sc1
    s_waitcnt vmcnt(10) lgkmcnt(15)
    v_mfma_f32_32x32x16_bf16 v[16:31], v[216:219], v[88:91], v[16:31]
    ds_read_b64_tr_b16 v[104:105], v194 offset:4096
    ds_read_b64_tr_b16 v[106:107], v194 offset:5120
    v_mfma_f32_32x32x16_bf16 v[32:47], v[220:223], v[88:91], v[32:47]
    ds_read_b64_tr_b16 v[108:109], v195 offset:4096
    ds_read_b64_tr_b16 v[110:111], v195 offset:5120
    v_mfma_f32_32x32x16_bf16 v[64:79], v[220:223], v[92:95], v[64:79]
    buffer_load_dwordx4 v[128:131], v251, s[68:71], s96 offen offset:1024 sc1
    v_mfma_f32_32x32x16_bf16 v[48:63], v[216:219], v[92:95], v[48:63]
    buffer_load_dwordx4 v[132:135], v252, s[68:71], s96 offen offset:1024 sc1
    s_waitcnt vmcnt(10) lgkmcnt(15)
    v_mfma_f32_32x32x16_bf16 v[16:31], v[176:179], v[136:139], v[16:31]
    ds_read_b64_tr_b16 v[80:81], v194 offset:6144
    ds_read_b64_tr_b16 v[82:83], v194 offset:7168
    v_mfma_f32_32x32x16_bf16 v[32:47], v[180:183], v[136:139], v[32:47]
    ds_read_b64_tr_b16 v[84:85], v195 offset:6144
    ds_read_b64_tr_b16 v[86:87], v195 offset:7168
    v_mfma_f32_32x32x16_bf16 v[64:79], v[180:183], v[140:143], v[64:79]
    buffer_load_dwordx4 v[144:147], v251, s[68:71], s97 offen offset:0 sc1
    v_mfma_f32_32x32x16_bf16 v[48:63], v[176:179], v[140:143], v[48:63]
    buffer_load_dwordx4 v[148:151], v252, s[68:71], s97 offen offset:0 sc1
    s_waitcnt vmcnt(10) lgkmcnt(15)
    v_mfma_f32_32x32x16_bf16 v[16:31], v[168:171], v[200:203], v[16:31]
    ds_read_b64_tr_b16 v[88:89], v192 offset:0
    ds_read_b64_tr_b16 v[90:91], v192 offset:1024
    ds_read_b64_tr_b16 v[92:93], v193 offset:0
    ds_read_b64_tr_b16 v[94:95], v193 offset:1024
    v_mfma_f32_32x32x16_bf16 v[32:47], v[172:175], v[200:203], v[32:47]
    buffer_load_dwordx4 v[120:123], v251, s[68:71], s97 offen offset:1024 sc1
    buffer_load_dwordx4 v[124:127], v252, s[68:71], s97 offen offset:1024 sc1
    v_mfma_f32_32x32x16_bf16 v[64:79], v[172:175], v[204:207], v[64:79]
    v_permlane32_swap_b32 v240, v242
    v_permlane32_swap_b32 v241, v243
    v_permlane32_swap_b32 v244, v246
    v_permlane32_swap_b32 v245, v247
    v_mfma_f32_32x32x16_bf16 v[48:63], v[168:171], v[204:207], v[48:63]
    v_lshlrev_b32 v208, 16, v240
    v_and_b32 v209, 0xffff0000, v240
    v_lshlrev_b32 v210, 16, v241
    s_waitcnt vmcnt(10) lgkmcnt(15)
    v_mfma_f32_32x32x16_bf16 v[16:31], v[184:187], v[152:155], v[16:31]
    ds_read_b64_tr_b16 v[136:137], v192 offset:2048
    ds_read_b64_tr_b16 v[138:139], v192 offset:3072
    ds_read_b64_tr_b16 v[140:141], v193 offset:2048
    ds_read_b64_tr_b16 v[142:143], v193 offset:3072
    v_mfma_f32_32x32x16_bf16 v[32:47], v[188:191], v[152:155], v[32:47]
    buffer_load_dwordx4 v[176:179], v251, s[68:71], s98 offen offset:0 sc1
    buffer_load_dwordx4 v[180:183], v252, s[68:71], s98 offen offset:0 sc1
    v_mfma_f32_32x32x16_bf16 v[64:79], v[188:191], v[156:159], v[64:79]
    s_mov_b32 s15, 200000
    v_and_b32 v211, 0xffff0000, v241
    v_lshlrev_b32 v212, 16, v242
    v_and_b32 v213, 0xffff0000, v242
    v_mfma_f32_32x32x16_bf16 v[48:63], v[184:187], v[156:159], v[48:63]
    v_lshlrev_b32 v214, 16, v243
    v_and_b32 v215, 0xffff0000, v243
    v_lshlrev_b32 v216, 16, v244
    v_and_b32 v217, 0xffff0000, v244
    s_waitcnt vmcnt(10) lgkmcnt(15)
    v_mfma_f32_32x32x16_bf16 v[16:31], v[96:99], v[160:163], v[16:31]
    ds_read_b64_tr_b16 v[200:201], v192 offset:4096
    ds_read_b64_tr_b16 v[202:203], v192 offset:5120
    ds_read_b64_tr_b16 v[204:205], v193 offset:4096
    ds_read_b64_tr_b16 v[206:207], v193 offset:5120
    buffer_load_dwordx4 v[168:171], v251, s[68:71], s98 offen offset:1024 sc1
    buffer_load_dwordx4 v[172:175], v252, s[68:71], s98 offen offset:1024 sc1
    v_mfma_f32_32x32x16_bf16 v[32:47], v[100:103], v[160:163], v[32:47]
    v_lshlrev_b32 v218, 16, v245
    v_and_b32 v219, 0xffff0000, v245
    v_lshlrev_b32 v220, 16, v246
    v_and_b32 v221, 0xffff0000, v246
    v_lshlrev_b32 v222, 16, v247
    v_and_b32 v223, 0xffff0000, v247
    v_mul_f32 v198, v198, v198
    v_mfma_f32_32x32x16_bf16 v[64:79], v[100:103], v[164:167], v[64:79]
    s_waitcnt vmcnt(10)
    v_xor_b32 v115, s81, v115
    v_xor_b32 v119, s81, v119
    v_or_b32 v9, v115, v119
    v_cmp_ne_u16 vcc, 0, v9
    v_mfma_f32_32x32x16_bf16 v[48:63], v[96:99], v[164:167], v[48:63]
    s_cbranch_vccnz L_or28
L_ok28:
    s_waitcnt vmcnt(26) lgkmcnt(15)
    v_mfma_f32_32x32x16_bf16 v[16:31], v[224:227], v[112:115], v[16:31]
    ds_read_b64_tr_b16 v[96:97], v192 offset:6144
    ds_read_b64_tr_b16 v[98:99], v192 offset:7168
    ds_read_b64_tr_b16 v[100:101], v193 offset:6144
    ds_read_b64_tr_b16 v[102:103], v193 offset:7168
    buffer_load_dwordx4 v[184:187], v251, s[68:71], s99 offen offset:0 sc1
    v_mfma_f32_32x32x16_bf16 v[32:47], v[228:231], v[112:115], v[32:47]
    buffer_load_dwordx4 v[188:191], v252, s[68:71], s99 offen offset:0 sc1
    buffer_load_dwordx4 v[152:155], v251, s[68:71], s99 offen offset:1024 sc1
    buffer_load_dwordx4 v[156:159], v252, s[68:71], s99 offen offset:1024 sc1
    v_mfma_f32_32x32x16_bf16 v[64:79], v[228:231], v[116:119], v[64:79]
    s_waitcnt vmcnt(12)
    v_xor_b32 v131, s81, v131
    v_xor_b32 v135, s81, v135
    v_or_b32 v9, v131, v135
    v_cmp_ne_u16 vcc, 0, v9
    v_mfma_f32_32x32x16_bf16 v[48:63], v[224:227], v[116:119], v[48:63]
    s_cbranch_vccnz L_or29
L_ok29:
    s_waitcnt lgkmcnt(15)
    v_mfma_f32_32x32x16_bf16 v[16:31], v[232:235], v[128:131], v[16:31]
    v_mfma_f32_32x32x16_bf16 v[32:47], v[236:239], v[128:131], v[32:47]
    v_mfma_f32_32x32x16_bf16 v[64:79], v[236:239], v[132:135], v[64:79]
    s_waitcnt vmcnt(10)
    v_xor_b32 v147, s81, v147
    v_xor_b32 v151, s81, v151
    v_or_b32 v9, v147, v151
    v_cmp_ne_u16 vcc, 0, v9
    v_mfma_f32_32x32x16_bf16 v[48:63], v[232:235], v[132:135], v[48:63]
    s_cbranch_vccnz L_or30
L_ok30:
    s_waitcnt lgkmcnt(0)
    s_waitcnt vmcnt(8)
    v_xor_b32 v123, s81, v123
    v_xor_b32 v127, s81, v127
    v_or_b32 v9, v123, v127
    v_cmp_ne_u16 vcc, 0, v9
    v_mfma_f32_32x32x16_bf16 v[64:79], v[108:111], v[148:151], v[64:79]
    s_cbranch_vccnz L_or31
L_ok31:
    s_nop 0
    s_waitcnt vmcnt(6)
    v_xor_b32 v179, s81, v179
    v_xor_b32 v183, s81, v183
    v_or_b32 v9, v179, v183
    v_cmp_ne_u16 vcc, 0, v9
    v_mfma_f32_32x32x16_bf16 v[64:79], v[84:87], v[124:127], v[64:79]
    s_cbranch_vccnz L_or32
L_ok32:
    s_nop 0
    s_waitcnt vmcnt(4)
    v_xor_b32 v171, s81, v171
    v_xor_b32 v175, s81, v175
    v_or_b32 v9, v171, v175
    v_cmp_ne_u16 vcc, 0, v9
    v_mfma_f32_32x32x16_bf16 v[64:79], v[92:95], v[180:183], v[64:79]
    s_cbranch_vccnz L_or33
L_ok33:
    s_nop 0
    s_waitcnt vmcnt(2)
    v_xor_b32 v187, s81, v187
    v_xor_b32 v191, s81, v191
    v_or_b32 v9, v187, v191
    v_cmp_ne_u16 vcc, 0, v9
    v_mfma_f32_32x32x16_bf16 v[64:79], v[140:143], v[172:175], v[64:79]
    s_cbranch_vccnz L_or34
L_ok34:
    s_nop 0
    s_waitcnt vmcnt(0)
    v_xor_b32 v155, s81, v155
    v_xor_b32 v159, s81, v159
    v_or_b32 v9, v155, v159
    v_cmp_ne_u16 vcc, 0, v9
    v_mfma_f32_32x32x16_bf16 v[64:79], v[204:207], v[188:191], v[64:79]
    s_cbranch_vccnz L_or35
L_ok35:
    s_nop 0
    v_mfma_f32_32x32x16_bf16 v[64:79], v[100:103], v[156:159], v[64:79]
    v_mfma_f32_32x32x16_bf16 v[48:63], v[104:107], v[148:151], v[48:63]
    s_nop 5
    v_mfma_f32_32x32x16_bf16 v[48:63], v[80:83], v[124:127], v[48:63]
    s_nop 3
    ds_write_b128 v253, v[64:67] offset:0
    v_mfma_f32_32x32x16_bf16 v[48:63], v[88:91], v[180:183], v[48:63]
    ds_write_b128 v253, v[68:71] offset:1024
    v_mfma_f32_32x32x16_bf16 v[48:63], v[136:139], v[172:175], v[48:63]
    ds_write_b128 v253, v[72:75] offset:2048
    v_mfma_f32_32x32x16_bf16 v[48:63], v[200:203], v[188:191], v[48:63]
    ds_write_b128 v253, v[76:79] offset:3072
    v_mfma_f32_32x32x16_bf16 v[48:63], v[96:99], v[156:159], v[48:63]
    v_mfma_f32_32x32x16_bf16 v[32:47], v[108:111], v[144:147], v[32:47]
    s_nop 5
    v_mfma_f32_32x32x16_bf16 v[32:47], v[84:87], v[120:123], v[32:47]
    s_nop 3
    ds_write_b128 v253, v[48:51] offset:4096
    v_mfma_f32_32x32x16_bf16 v[32:47], v[92:95], v[176:179], v[32:47]
    ds_write_b128 v253, v[52:55] offset:5120
    v_mfma_f32_32x32x16_bf16 v[32:47], v[140:143], v[168:171], v[32:47]
    ds_write_b128 v253, v[56:59] offset:6144
    v_mfma_f32_32x32x16_bf16 v[32:47], v[204:207], v[184:187], v[32:47]
    ds_write_b128 v253, v[60:63] offset:7168
    v_mfma_f32_32x32x16_bf16 v[32:47], v[100:103], v[152:155], v[32:47]
    v_mfma_f32_32x32x16_bf16 v[16:31], v[104:107], v[144:147], v[16:31]
    s_nop 5
    v_mfma_f32_32x32x16_bf16 v[16:31], v[80:83], v[120:123], v[16:31]
    s_nop 3
    ds_write_b128 v253, v[32:35] offset:32768
    v_mfma_f32_32x32x16_bf16 v[16:31], v[88:91], v[176:179], v[16:31]
    ds_write_b128 v253, v[36:39] offset:33792
    v_mfma_f32_32x32x16_bf16 v[16:31], v[136:139], v[168:171], v[16:31]
    ds_write_b128 v253, v[40:43] offset:34816
    v_mfma_f32_32x32x16_bf16 v[16:31], v[200:203], v[184:187], v[16:31]
    ds_write_b128 v253, v[44:47] offset:35840
    ds_write_b32 v254, v255 offset:65280
    v_mfma_f32_32x32x16_bf16 v[16:31], v[96:99], v[152:155], v[16:31]
    s_mov_b32 s15, 200000
L_g1:
    ds_read_b32 v9, v6 offset:65280
    s_waitcnt lgkmcnt(0)
    v_cmp_gt_u32 vcc, 1, v9
    s_cbranch_vccz L_g1_ok
    s_sub_u32 s15, s15, 1
    s_cbranch_scc0 L_g1
L_g1_ok:
    ds_read_b128 v[96:99], v2 offset:4096
    ds_read_b128 v[112:115], v3 offset:32768
    ds_read_b128 v[128:131], v4 offset:0
    ds_read_b128 v[100:103], v2 offset:5120
    ds_read_b128 v[116:119], v3 offset:33792
    ds_read_b128 v[132:135], v4 offset:1024
    ds_read_b128 v[104:107], v2 offset:6144
    ds_read_b128 v[120:123], v3 offset:34816
    ds_read_b128 v[136:139], v4 offset:2048
    ds_read_b128 v[108:111], v2 offset:7168
    ds_read_b128 v[124:127], v3 offset:35840
    ds_read_b128 v[140:143], v4 offset:3072
    s_waitcnt lgkmcnt(10)
    v_pk_add_f32 v[96:97], v[96:97], v[112:113]
    v_pk_add_f32 v[98:99], v[98:99], v[114:115]
    s_waitcnt lgkmcnt(9)
    v_pk_add_f32 v[16:17], v[16:17], v[128:129]
    v_pk_add_f32 v[18:19], v[18:19], v[130:131]
    v_pk_add_f32 v[16:17], v[16:17], v[96:97]
    v_pk_add_f32 v[18:19], v[18:19], v[98:99]
    v_fma_f32 v16, v16, v198, v208
    v_fma_f32 v17, v17, v198, v209
    v_fma_f32 v18, v18, v198, v210
    v_fma_f32 v19, v19, v198, v211
    v_cvt_pk_bf16_f32 v80, v16, v17
    v_cvt_pk_bf16_f32 v81, v18, v19
    s_waitcnt lgkmcnt(7)
    v_pk_add_f32 v[100:101], v[100:101], v[116:117]
    v_pk_add_f32 v[102:103], v[102:103], v[118:119]
    s_waitcnt lgkmcnt(6)
    v_pk_add_f32 v[20:21], v[20:21], v[132:133]
    v_pk_add_f32 v[22:23], v[22:23], v[134:135]
    v_pk_add_f32 v[20:21], v[20:21], v[100:101]
    v_pk_add_f32 v[22:23], v[22:23], v[102:103]
    v_fma_f32 v20, v20, v198, v212
    v_fma_f32 v21, v21, v198, v213
    v_fma_f32 v22, v22, v198, v214
    v_fma_f32 v23, v23, v198, v215
    v_cvt_pk_bf16_f32 v82, v20, v21
    v_cvt_pk_bf16_f32 v83, v22, v23
    s_nop 0
    v_permlane32_swap_b32 v80, v82
    v_permlane32_swap_b32 v81, v83
    buffer_store_dwordx4 v[80:83], v199, s[64:67], s78 offen offset:0
    s_waitcnt lgkmcnt(4)
    v_pk_add_f32 v[104:105], v[104:105], v[120:121]
    v_pk_add_f32 v[106:107], v[106:107], v[122:123]
    s_waitcnt lgkmcnt(3)
    v_pk_add_f32 v[24:25], v[24:25], v[136:137]
    v_pk_add_f32 v[26:27], v[26:27], v[138:139]
    v_pk_add_f32 v[24:25], v[24:25], v[104:105]
    v_pk_add_f32 v[26:27], v[26:27], v[106:107]
    v_fma_f32 v24, v24, v198, v216
    v_fma_f32 v25, v25, v198, v217
    v_fma_f32 v26, v26, v198, v218
    v_fma_f32 v27, v27, v198, v219
    v_cvt_pk_bf16_f32 v84, v24, v25
    v_cvt_pk_bf16_f32 v85, v26, v27
    s_waitcnt lgkmcnt(1)
    v_pk_add_f32 v[108:109], v[108:109], v[124:125]
    v_pk_add_f32 v[110:111], v[110:111], v[126:127]
    s_waitcnt lgkmcnt(0)
    v_pk_add_f32 v[28:29], v[28:29], v[140:141]
    v_pk_add_f32 v[30:31], v[30:31], v[142:143]
    v_pk_add_f32 v[28:29], v[28:29], v[108:109]
    v_pk_add_f32 v[30:31], v[30:31], v[110:111]
    v_fma_f32 v28, v28, v198, v220
    v_fma_f32 v29, v29, v198, v221
    v_fma_f32 v30, v30, v198, v222
    v_fma_f32 v31, v31, v198, v223
    v_cvt_pk_bf16_f32 v86, v28, v29
    v_cvt_pk_bf16_f32 v87, v30, v31
    s_nop 0
    v_permlane32_swap_b32 v84, v86
    v_permlane32_swap_b32 v85, v87
    buffer_store_dwordx4 v[84:87], v199, s[64:67], s78 offen offset:32
    s_endpgm
L_spare:
    s_mov_b64 s[96:97], s[72:73]
    s_lshr_b32 s7, s3, 8
    s_lshl3_add_u32 s7, s7, 16
    s_load_dwordx2 s[72:73], s[0:1], s7
    s_load_dwordx2 s[68:69], s[0:1], 88
    s_lshr_b32 s3, s3, 6
    s_bitcmp1_b32 s2, 2
    s_cselect_b32 s9, 15, 14
    s_mov_b32 s85, 0x67543210
    s_cselect_b32 s85, 0x9ba8fedc, s85
    s_lshl_b32 s10, s21, 2
    s_lshr_b32 s85, s85, s10
    s_and_b32 s85, s85, 15
    s_mov_b32 s70, 16777216
    s_mov_b32 s71, s43
    v_lshlrev_b32 v8, 4, v0
    v_mov_b32 v7, 9699328
    s_mov_b32 s5, s9
    s_lshr_b32 s9, s3, 2
    s_mov_b32 s74, 25088
    s_mov_b32 s75, 0x20000
    s_mul_i32 s12, s9, 28672
    s_and_b32 s95, s8, 6
    s_lshl_b32 s9, s23, 4
    v_lshrrev_b32 v9, 2, v0
    v_add_u32 v12, s9, v9
    v_mul_u32_u24 v9, 896, v12
    v_and_b32 v11, 3, v0
    v_lshl_add_u32 v6, v11, 4, v9
    s_mul_i32 s9, s85, 56
    v_add_u32 v6, s9, v6
    s_lshl_b32 s13, s23, 10
    v_mul_u32_u24 v4, 56, v12
    v_lshl_add_u32 v4, v11, 4, v4
    s_add_u32 s12, s12, s13
    s_and_b32 s7, s5, 1
    s_lshl1_add_u32 s7, s4, s7
    s_and_b32 s9, s3, 1
    s_lshl1_add_u32 s80, s7, s9
    s_mul_i32 s14, s9, 28672
    s_lshr_b32 s9, s3, 1
    s_lshl2_add_u32 s7, s80, s9
    s_lshl_b32 s7, s7, 3
    v_lshrrev_b32 v9, 3, v0
    v_add_u32 v9, s7, v9
    v_bfe_u32 v10, v9, 1, 3
    v_mul_u32_u24 v9, 896, v9
    v_and_b32 v11, 7, v0
    v_xor_b32 v11, v11, v10
    v_lshl_add_u32 v2, v11, 4, v9
    s_lshl_b32 s9, s9, 10
    s_add_u32 s11, s14, s9
    s_mov_b32 s82, s95
    s_mov_b32 s83, s95
    s_waitcnt lgkmcnt(0)
    buffer_load_dword v7, v7, s[68:71], 0 offen sc1
    s_add_u32 m0, s12, 57344
    s_mul_i32 s7, s83, 3584
    buffer_load_dwordx4 v4, s[72:75], s7 offen lds
    s_add_u32 s83, s83, 1
    s_cmp_eq_u32 s83, 7
    s_cselect_b32 s83, 0, s83
    s_add_u32 m0, s12, 61440
    s_mul_i32 s7, s83, 3584
    buffer_load_dwordx4 v4, s[72:75], s7 offen lds
    s_add_u32 s83, s83, 1
    s_cmp_eq_u32 s83, 7
    s_cselect_b32 s83, 0, s83
    s_add_u32 m0, s11, 0
    s_lshl_b32 s7, s82, 7
    buffer_load_dwordx4 v2, s[40:43], s7 offen lds
    s_add_u32 s82, s82, 1
    s_cmp_eq_u32 s82, 7
    s_cselect_b32 s82, 0, s82
    s_add_u32 m0, s11, 4096
    s_lshl_b32 s7, s82, 7
    buffer_load_dwordx4 v2, s[40:43], s7 offen lds
    s_add_u32 s82, s82, 1
    s_cmp_eq_u32 s82, 7
    s_cselect_b32 s82, 0, s82
    s_add_u32 m0, s11, 8192
    s_lshl_b32 s7, s82, 7
    buffer_load_dwordx4 v2, s[40:43], s7 offen lds
    s_add_u32 s82, s82, 1
    s_cmp_eq_u32 s82, 7
    s_cselect_b32 s82, 0, s82
    s_add_u32 m0, s11, 12288
    s_lshl_b32 s7, s82, 7
    buffer_load_dwordx4 v2, s[40:43], s7 offen lds
    s_add_u32 s82, s82, 1
    s_cmp_eq_u32 s82, 7
    s_cselect_b32 s82, 0, s82
    s_mov_b32 s98, L_code_end-L_pc
    s_mov_b32 s99, s43
    s_lshr_b32 s7, s2, 3
    s_lshl3_add_u32 s7, s7, s3
    s_lshl_b32 s7, s7, 6
    s_buffer_load_dword s15, s[96:99], s7 offset:0
    s_buffer_load_dword s15, s[96:99], s7 offset:16384
    s_buffer_load_dword s15, s[96:99], s7 offset:32768
    s_load_dwordx2 s[44:45], s[0:1], 8
    s_mov_b32 s46, 401408
    s_mov_b32 s47, s43
    s_load_dwordx2 s[56:57], s[0:1], 64
    s_mov_b32 s58, 1605632
    s_mov_b32 s59, s43
    s_load_dwordx2 s[60:61], s[0:1], 32
    s_mov_b32 s62, 401408
    s_mov_b32 s63, s43
    s_mov_b32 s76, 143360
    s_mov_b32 s77, 153616
    v_mov_b32 v13, 0x3f803f80
    v_and_b32 v9, 31, v0
    v_bfe_u32 v10, v0, 1, 3
    v_lshrrev_b32 v11, 5, v0
    v_xor_b32 v10, v10, v11
    v_lshlrev_b32 v9, 7, v9
    v_lshl_add_u32 v140, v10, 4, v9
    v_add_u32 v136, s14, v140
    v_xor_b32 v137, 32, v136
    v_xor_b32 v138, 64, v136
    v_xor_b32 v139, 96, v136
    v_bfe_u32 v10, v0, 4, 1
    v_bfe_u32 v12, v0, 2, 2
    v_and_b32 v185, 3, v0
    v_lshlrev_b32 v145, 9, v11
    v_lshl_add_u32 v145, v12, 6, v145
    v_lshl_add_u32 v145, v10, 5, v145
    v_lshl_add_u32 v145, v185, 3, v145
    s_bitcmp1_b32 s3, 1
    s_cselect_b32 s7, 28672, 0
    s_add_u32 s7, s7, 57344
    v_add_u32 v144, s7, v145
    v_mov_b32 v177, 0
    v_mov_b32 v178, 0
    v_mov_b32 v179, 0
    s_lshl_b32 s7, s23, 12
    s_add_u32 s7, s7, 143360
    v_add_u32 v9, s7, v8
    s_lshl_b32 s7, s3, 8
    s_add_u32 s7, s7, 159744
    v_lshl_add_u32 v10, v0, 2, s7
    v_add_u32 v11, s11, v8
    s_add_u32 s7, s12, 57344
    v_add_u32 v12, s7, v145
    s_add_u32 m0, s11, 16384
    s_lshl_b32 s7, s82, 7
    buffer_load_dwordx4 v2, s[40:43], s7 offen lds
    s_add_u32 s82, s82, 1
    s_cmp_eq_u32 s82, 7
    s_cselect_b32 s82, 0, s82
    s_add_u32 m0, s11, 20480
    s_lshl_b32 s7, s82, 7
    buffer_load_dwordx4 v2, s[40:43], s7 offen lds
    s_add_u32 s82, s82, 1
    s_cmp_eq_u32 s82, 7
    s_cselect_b32 s82, 0, s82
    s_add_u32 m0, s11, 24576
    s_lshl_b32 s7, s82, 7
    buffer_load_dwordx4 v2, s[40:43], s7 offen lds
    s_add_u32 s82, s82, 1
    s_cmp_eq_u32 s82, 7
    s_cselect_b32 s82, 0, s82
    s_waitcnt vmcnt(4)
    ds_read_b64_tr_b16 v[60:61], v12 offset:0
    ds_read_b64_tr_b16 v[62:63], v12 offset:256
    ds_read_b64_tr_b16 v[64:65], v12 offset:4096
    ds_read_b64_tr_b16 v[66:67], v12 offset:4352
    ds_read_b128 v[32:35], v11 offset:0
    ds_read_b128 v[36:39], v11 offset:4096
    ds_read_b128 v[40:43], v11 offset:8192
    v_readfirstlane_b32 s6, v7
    s_mul_i32 s6, s6, 0x9E3779B1
    s_add_u32 s6, s6, 0x7F4A7C15
    s_add_u32 m0, s12, 65536
    s_mul_i32 s7, s83, 3584
    buffer_load_dwordx4 v4, s[72:75], s7 offen lds
    s_add_u32 s83, s83, 1
    s_cmp_eq_u32 s83, 7
    s_cselect_b32 s83, 0, s83
    s_add_u32 m0, s12, 69632
    s_mul_i32 s7, s83, 3584
    buffer_load_dwordx4 v4, s[72:75], s7 offen lds
    s_add_u32 s83, s83, 1
    s_cmp_eq_u32 s83, 7
    s_cselect_b32 s83, 0, s83
    s_waitcnt lgkmcnt(0)
    v_dot2c_f32_bf16 v179, v60, v13
    v_dot2c_f32_bf16 v179, v61, v13
    v_dot2c_f32_bf16 v179, v62, v13
    v_dot2c_f32_bf16 v179, v63, v13
    v_dot2c_f32_bf16 v179, v64, v13
    v_dot2c_f32_bf16 v179, v65, v13
    v_dot2c_f32_bf16 v179, v66, v13
    v_dot2c_f32_bf16 v179, v67, v13
    v_dot2c_f32_bf16 v177, v32, v13
    v_dot2c_f32_bf16 v178, v32, v32
    v_dot2c_f32_bf16 v177, v33, v13
    v_dot2c_f32_bf16 v178, v33, v33
    v_dot2c_f32_bf16 v177, v34, v13
    v_dot2c_f32_bf16 v178, v34, v34
    v_dot2c_f32_bf16 v177, v35, v13
    v_dot2c_f32_bf16 v178, v35, v35
    v_dot2c_f32_bf16 v177, v36, v13
    v_dot2c_f32_bf16 v178, v36, v36
    v_dot2c_f32_bf16 v177, v37, v13
    v_dot2c_f32_bf16 v178, v37, v37
    v_dot2c_f32_bf16 v177, v38, v13
    v_dot2c_f32_bf16 v178, v38, v38
    v_dot2c_f32_bf16 v177, v39, v13
    v_dot2c_f32_bf16 v178, v39, v39
    v_dot2c_f32_bf16 v177, v40, v13
    v_dot2c_f32_bf16 v178, v40, v40
    v_dot2c_f32_bf16 v177, v41, v13
    v_dot2c_f32_bf16 v178, v41, v41
    v_dot2c_f32_bf16 v177, v42, v13
    v_dot2c_f32_bf16 v178, v42, v42
    v_dot2c_f32_bf16 v177, v43, v13
    v_dot2c_f32_bf16 v178, v43, v43
    s_add_u32 m0, s12, 73728
    s_mul_i32 s7, s83, 3584
    buffer_load_dwordx4 v4, s[72:75], s7 offen lds
    s_add_u32 s83, s83, 1
    s_cmp_eq_u32 s83, 7
    s_cselect_b32 s83, 0, s83
    s_add_u32 m0, s12, 77824
    s_mul_i32 s7, s83, 3584
    buffer_load_dwordx4 v4, s[72:75], s7 offen lds
    s_add_u32 s83, s83, 1
    s_cmp_eq_u32 s83, 7
    s_cselect_b32 s83, 0, s83
    s_add_u32 m0, s12, 81920
    s_mul_i32 s7, s83, 3584
    buffer_load_dwordx4 v4, s[72:75], s7 offen lds
    s_add_u32 s83, s83, 1
    s_cmp_eq_u32 s83, 7
    s_cselect_b32 s83, 0, s83
    s_waitcnt vmcnt(5)
    ds_read_b128 v[44:47], v11 offset:12288
    ds_read_b128 v[48:51], v11 offset:16384
    ds_read_b128 v[52:55], v11 offset:20480
    ds_read_b128 v[56:59], v11 offset:24576
    s_lshr_b32 s7, s3, 1
    s_lshl2_add_u32 s7, s80, s7
    s_lshl_b32 s7, s7, 3
    v_lshrrev_b32 v188, 3, v0
    v_add_u32 v188, s7, v188
    v_and_b32 v189, 63, v188
    v_lshlrev_b32 v188, 4, v188
    v_lshlrev_b32 v189, 2, v189
    v_add_u32 v189, 162816, v189
    v_mov_b32 v186, s6
    v_mov_b32 v187, s6
    s_waitcnt lgkmcnt(3)
    v_dot2c_f32_bf16 v177, v44, v13
    v_dot2c_f32_bf16 v178, v44, v44
    v_dot2c_f32_bf16 v177, v45, v13
    v_dot2c_f32_bf16 v178, v45, v45
    v_dot2c_f32_bf16 v177, v46, v13
    v_dot2c_f32_bf16 v178, v46, v46
    v_dot2c_f32_bf16 v177, v47, v13
    v_dot2c_f32_bf16 v178, v47, v47
    s_waitcnt lgkmcnt(2)
    v_dot2c_f32_bf16 v177, v48, v13
    v_dot2c_f32_bf16 v178, v48, v48
    v_dot2c_f32_bf16 v177, v49, v13
    v_dot2c_f32_bf16 v178, v49, v49
    v_dot2c_f32_bf16 v177, v50, v13
    v_dot2c_f32_bf16 v178, v50, v50
    v_dot2c_f32_bf16 v177, v51, v13
    v_dot2c_f32_bf16 v178, v51, v51
    s_waitcnt lgkmcnt(1)
    v_dot2c_f32_bf16 v177, v52, v13
    v_dot2c_f32_bf16 v178, v52, v52
    v_dot2c_f32_bf16 v177, v53, v13
    v_dot2c_f32_bf16 v178, v53, v53
    v_dot2c_f32_bf16 v177, v54, v13
    v_dot2c_f32_bf16 v178, v54, v54
    v_dot2c_f32_bf16 v177, v55, v13
    v_dot2c_f32_bf16 v178, v55, v55
    s_waitcnt lgkmcnt(0)
    v_dot2c_f32_bf16 v177, v56, v13
    v_dot2c_f32_bf16 v178, v56, v56
    v_dot2c_f32_bf16 v177, v57, v13
    v_dot2c_f32_bf16 v178, v57, v57
    v_dot2c_f32_bf16 v177, v58, v13
    v_dot2c_f32_bf16 v178, v58, v58
    v_dot2c_f32_bf16 v177, v59, v13
    v_dot2c_f32_bf16 v178, v59, v59
    s_nop 1
    v_add_f32_dpp v177, v177, v177 quad_perm:[1,0,3,2] row_mask:0xf bank_mask:0xf
    v_add_f32_dpp v178, v178, v178 quad_perm:[1,0,3,2] row_mask:0xf bank_mask:0xf
    s_nop 0
    v_add_f32_dpp v177, v177, v177 quad_perm:[2,3,0,1] row_mask:0xf bank_mask:0xf
    v_add_f32_dpp v178, v178, v178 quad_perm:[2,3,0,1] row_mask:0xf bank_mask:0xf
    s_nop 0
    v_add_f32_dpp v177, v177, v177 row_half_mirror row_mask:0xf bank_mask:0xf
    v_add_f32_dpp v178, v178, v178 row_half_mirror row_mask:0xf bank_mask:0xf
    s_nop 0
    v_mul_f32 v177, 0x3b124925, v177
    v_mul_f32 v178, 0x3b124925, v178
    v_fma_f32 v178, -v177, v177, v178
    v_max_f32 v178, 0, v178
    v_cvt_pk_bf16_f32 v184, -v177, -v177
    v_cvt_pk_bf16_f32 v190, v178, v178
    v_and_b32 v190, 0xffff0000, v190
    v_add_f32 v190, 0x3727c5ac, v190
    v_cvt_pk_bf16_f32 v190, v190, v190
    v_and_b32 v190, 0xffff0000, v190
    v_sqrt_f32 v190, v190
    s_nop 0
    v_cvt_pk_bf16_f32 v190, v190, v190
    v_and_b32 v190, 0xffff0000, v190
    v_rcp_f32 v185, v190
    s_mov_b32 s7, 9732096
    ds_write_b32 v189, v184
    ds_write_b32 v189, v185 offset:512
    s_mov_b32 exec_lo, 0x01010101
    s_mov_b32 exec_hi, 0x01010101
    buffer_store_dwordx4 v[184:187], v188, s[68:71], s7 offen sc1
    s_mov_b64 exec, -1
    s_waitcnt vmcnt(4)
    ds_read_b64_tr_b16 v[68:69], v12 offset:8192
    ds_read_b64_tr_b16 v[70:71], v12 offset:8448
    ds_read_b64_tr_b16 v[72:73], v12 offset:12288
    ds_read_b64_tr_b16 v[74:75], v12 offset:12544
    s_barrier
    s_waitcnt lgkmcnt(0)
    v_dot2c_f32_bf16 v179, v68, v13
    v_dot2c_f32_bf16 v179, v69, v13
    v_dot2c_f32_bf16 v179, v70, v13
    v_dot2c_f32_bf16 v179, v71, v13
    v_dot2c_f32_bf16 v179, v72, v13
    v_dot2c_f32_bf16 v179, v73, v13
    v_dot2c_f32_bf16 v179, v74, v13
    v_dot2c_f32_bf16 v179, v75, v13
    s_cmp_lt_u32 s3, 4
    s_cbranch_scc1 L_sp_lo
    s_mov_b32 s9, s80
    s_bitcmp1_b32 s3, 1
    s_cbranch_scc1 L_sp_v
    ds_read_b128 v[96:99], v136 offset:0
    ds_read_b64_tr_b16 v[100:101], v144 offset:0
    ds_read_b64_tr_b16 v[102:103], v144 offset:256
    ds_read_b128 v[104:107], v137 offset:0
    ds_read_b64_tr_b16 v[108:109], v144 offset:1024
    ds_read_b64_tr_b16 v[110:111], v144 offset:1280
    ds_read_b128 v[112:115], v138 offset:0
    ds_read_b64_tr_b16 v[116:117], v144 offset:2048
    ds_read_b64_tr_b16 v[118:119], v144 offset:2304
    ds_read_b128 v[120:123], v139 offset:0
    ds_read_b64_tr_b16 v[124:125], v144 offset:3072
    ds_read_b64_tr_b16 v[126:127], v144 offset:3328
    s_waitcnt lgkmcnt(9)
    v_mfma_f32_32x32x16_bf16 v[16:31], v[100:103], v[96:99], 0
    ds_read_b128 v[96:99], v136 offset:8192
    ds_read_b64_tr_b16 v[100:101], v144 offset:8192
    ds_read_b64_tr_b16 v[102:103], v144 offset:8448
    s_waitcnt lgkmcnt(9)
    v_mfma_f32_32x32x16_bf16 v[16:31], v[108:111], v[104:107], v[16:31]
    ds_read_b128 v[104:107], v137 offset:8192
    ds_read_b64_tr_b16 v[108:109], v144 offset:9216
    ds_read_b64_tr_b16 v[110:111], v144 offset:9472
    s_waitcnt lgkmcnt(9)
    v_mfma_f32_32x32x16_bf16 v[16:31], v[116:119], v[112:115], v[16:31]
    ds_read_b128 v[112:115], v138 offset:8192
    ds_read_b64_tr_b16 v[116:117], v144 offset:10240
    ds_read_b64_tr_b16 v[118:119], v144 offset:10496
    s_waitcnt lgkmcnt(9)
    v_mfma_f32_32x32x16_bf16 v[16:31], v[124:127], v[120:123], v[16:31]
    ds_read_b128 v[120:123], v139 offset:8192
    ds_read_b64_tr_b16 v[124:125], v144 offset:11264
    ds_read_b64_tr_b16 v[126:127], v144 offset:11520
    s_waitcnt lgkmcnt(9)
    v_mfma_f32_32x32x16_bf16 v[16:31], v[100:103], v[96:99], v[16:31]
    s_waitcnt lgkmcnt(6)
    v_mfma_f32_32x32x16_bf16 v[16:31], v[108:111], v[104:107], v[16:31]
    s_waitcnt lgkmcnt(3)
    v_mfma_f32_32x32x16_bf16 v[16:31], v[116:119], v[112:115], v[16:31]
    s_waitcnt lgkmcnt(0)
    v_mfma_f32_32x32x16_bf16 v[16:31], v[124:127], v[120:123], v[16:31]
    s_waitcnt vmcnt(1)
    ds_read_b64_tr_b16 v[60:61], v12 offset:16384
    ds_read_b64_tr_b16 v[62:63], v12 offset:16640
    ds_read_b64_tr_b16 v[64:65], v12 offset:20480
    ds_read_b64_tr_b16 v[66:67], v12 offset:20736
    ds_read_b64_tr_b16 v[68:69], v12 offset:24576
    ds_read_b64_tr_b16 v[70:71], v12 offset:24832
    s_waitcnt lgkmcnt(0)
    v_dot2c_f32_bf16 v179, v60, v13
    v_dot2c_f32_bf16 v179, v61, v13
    v_dot2c_f32_bf16 v179, v62, v13
    v_dot2c_f32_bf16 v179, v63, v13
    v_dot2c_f32_bf16 v179, v64, v13
    v_dot2c_f32_bf16 v179, v65, v13
    v_dot2c_f32_bf16 v179, v66, v13
    v_dot2c_f32_bf16 v179, v67, v13
    v_dot2c_f32_bf16 v179, v68, v13
    v_dot2c_f32_bf16 v179, v69, v13
    v_dot2c_f32_bf16 v179, v70, v13
    v_dot2c_f32_bf16 v179, v71, v13
    s_nop 2
    ds_write_b32 v10, v179
    s_waitcnt lgkmcnt(0)
    s_barrier
    s_and_b32 s7, s3, 1
    s_lshl_b32 s7, s7, 7
    s_add_u32 s7, s7, 162816
    v_lshlrev_b32 v184, 2, v0
    v_add_u32 v184, 159744, v184
    v_and_b32 v168, 31, v0
    v_lshl_add_u32 v185, v168, 2, s7
    ds_read2st64_b32 v[32:33], v184 offset0:0 offset1:1
    ds_read2st64_b32 v[34:35], v184 offset0:2 offset1:3
    ds_read_b32 v128, v185
    ds_read_b32 v183, v185 offset:512
    ds_read_b128 v[96:99], v136 offset:16384
    ds_read_b64_tr_b16 v[100:101], v144 offset:16384
    ds_read_b64_tr_b16 v[102:103], v144 offset:16640
    ds_read_b128 v[104:107], v137 offset:16384
    ds_read_b64_tr_b16 v[108:109], v144 offset:17408
    ds_read_b64_tr_b16 v[110:111], v144 offset:17664
    ds_read_b128 v[112:115], v138 offset:16384
    ds_read_b64_tr_b16 v[116:117], v144 offset:18432
    ds_read_b64_tr_b16 v[118:119], v144 offset:18688
    ds_read_b128 v[120:123], v139 offset:16384
    ds_read_b64_tr_b16 v[124:125], v144 offset:19456
    ds_read_b64_tr_b16 v[126:127], v144 offset:19712
    s_waitcnt lgkmcnt(9)
    v_mfma_f32_32x32x16_bf16 v[16:31], v[100:103], v[96:99], v[16:31]
    v_add_f32 v32, v32, v33
    v_add_f32 v34, v34, v35
    ds_read_b128 v[96:99], v136 offset:24576
    ds_read_b64_tr_b16 v[100:101], v144 offset:24576
    ds_read_b64_tr_b16 v[102:103], v144 offset:24832
    s_waitcnt lgkmcnt(9)
    v_mfma_f32_32x32x16_bf16 v[16:31], v[108:111], v[104:107], v[16:31]
    v_add_f32 v179, v32, v34
    v_mov_b32 v188, v179
    v_cmp_gt_u32 vcc, 32, v0
    s_nop 0
    v_permlane32_swap_b32 v179, v188
    v_add_f32 v179, v179, v188
    ds_read_b128 v[104:107], v137 offset:24576
    ds_read_b64_tr_b16 v[108:109], v144 offset:25600
    ds_read_b64_tr_b16 v[110:111], v144 offset:25856
    s_waitcnt lgkmcnt(9)
    v_mfma_f32_32x32x16_bf16 v[16:31], v[116:119], v[112:115], v[16:31]
    v_mov_b32 v129, 0
    v_cndmask_b32 v179, 0, v179, vcc
    ds_read_b128 v[112:115], v138 offset:24576
    ds_read_b64_tr_b16 v[116:117], v144 offset:26624
    ds_read_b64_tr_b16 v[118:119], v144 offset:26880
    s_waitcnt lgkmcnt(9)
    v_mfma_f32_32x32x16_bf16 v[16:31], v[124:127], v[120:123], v[16:31]
    v_cvt_pk_bf16_f32 v184, v179, v179
    v_and_b32 v184, 0xffff0000, v184
    ds_read_b128 v[120:123], v139 offset:24576
    ds_read_b64_tr_b16 v[124:125], v144 offset:27648
    ds_read_b64_tr_b16 v[126:127], v144 offset:27904
    s_waitcnt lgkmcnt(9)
    v_mfma_f32_32x32x16_bf16 v[16:31], v[100:103], v[96:99], v[16:31]
    v_sub_f32 v179, v179, v184
    v_cvt_pk_bf16_f32 v132, v184, v179
    s_waitcnt lgkmcnt(6)
    v_mfma_f32_32x32x16_bf16 v[16:31], v[108:111], v[104:107], v[16:31]
    v_mov_b32 v130, 0
    v_mov_b32 v131, 0
    s_waitcnt lgkmcnt(3)
    v_mfma_f32_32x32x16_bf16 v[16:31], v[116:119], v[112:115], v[16:31]
    v_mov_b32 v133, 0
    v_mov_b32 v134, 0
    s_waitcnt lgkmcnt(0)
    v_mfma_f32_32x32x16_bf16 v[16:31], v[124:127], v[120:123], v[16:31]
    v_mov_b32 v135, 0
    s_nop 0
    s_nop 0
    v_mfma_f32_32x32x16_bf16 v[16:31], v[132:135], v[128:131], v[16:31]
    s_barrier
    ds_read_b128 v[48:51], v9 offset:0
    ds_read_b128 v[52:55], v9 offset:1024
    ds_read_b128 v[56:59], v9 offset:2048
    ds_read_b128 v[60:63], v9 offset:3072
    s_nop 6
    v_mov_b32 v187, 0x3f80
    s_lshl_b32 s7, s9, 12
    s_add_u32 s7, s7, 9437184
    s_waitcnt lgkmcnt(2)
    v_add_f32 v16, v16, v48
    v_add_f32 v17, v17, v49
    v_add_f32 v18, v18, v50
    v_add_f32 v19, v19, v51
    v_add_f32 v20, v20, v52
    v_add_f32 v21, v21, v53
    v_add_f32 v22, v22, v54
    v_add_f32 v23, v23, v55
    v_mul_f32 v16, v183, v16
    v_mul_f32 v17, v183, v17
    v_mul_f32 v18, v183, v18
    v_mul_f32 v19, v183, v19
    v_mul_f32 v20, v183, v20
    v_mul_f32 v21, v183, v21
    v_mul_f32 v22, v183, v22
    v_mul_f32 v23, v183, v23
    v_cvt_pk_bf16_f32 v160, v16, v17
    v_cvt_pk_bf16_f32 v161, v18, v19
    v_cvt_pk_bf16_f32 v162, v20, v21
    v_cvt_pk_bf16_f32 v163, v22, v23
    buffer_store_dwordx4 v[160:163], v8, s[68:71], s7 offen offset:0 sc1
    s_waitcnt lgkmcnt(0)
    v_add_f32 v24, v24, v56
    v_add_f32 v25, v25, v57
    v_add_f32 v26, v26, v58
    v_add_f32 v27, v27, v59
    v_add_f32 v28, v28, v60
    v_add_f32 v29, v29, v61
    v_add_f32 v30, v30, v62
    v_add_f32 v31, v31, v63
    v_mul_f32 v24, v183, v24
    v_mul_f32 v25, v183, v25
    v_mul_f32 v26, v183, v26
    v_mul_f32 v27, v183, v27
    v_mul_f32 v28, v183, v28
    v_mul_f32 v29, v183, v29
    v_mul_f32 v30, v183, v30
    v_mul_f32 v31, v183, v31
    v_cvt_pk_bf16_f32 v164, v24, v25
    v_cvt_pk_bf16_f32 v165, v26, v27
    v_cvt_pk_bf16_f32 v166, v28, v29
    v_cvt_pk_bf16_f32 v167, v30, v31
    v_cndmask_b32 v166, v13, v166, vcc
    v_cndmask_b32 v167, v187, v167, vcc
    buffer_store_dwordx4 v[164:167], v8, s[68:71], s7 offen offset:1024 sc1
    v_mul_f32 v185, v28, v28
    v_mul_f32 v186, v16, v16
    v_fmac_f32 v185, v29, v29
    v_fmac_f32 v185, v30, v30
    v_fmac_f32 v185, v31, v31
    v_cndmask_b32 v185, 0, v185, vcc
    v_fmac_f32 v185, v17, v17
    v_fmac_f32 v186, v18, v18
    v_fmac_f32 v185, v19, v19
    v_fmac_f32 v186, v20, v20
    v_fmac_f32 v185, v21, v21
    v_fmac_f32 v186, v22, v22
    v_fmac_f32 v185, v23, v23
    v_fmac_f32 v186, v24, v24
    v_fmac_f32 v185, v25, v25
    v_fmac_f32 v186, v26, v26
    v_fmac_f32 v185, v27, v27
    v_add_f32 v185, v185, v186
    v_mov_b32 v186, v185
    s_nop 1
    v_permlane32_swap_b32 v185, v186
    v_add_f32 v185, v185, v186
    s_nop 1
    v_max_f32_dpp v185, v185, v185 row_shr:1 row_mask:0xf bank_mask:0xf bound_ctrl:0
    s_nop 1
    v_max_f32_dpp v185, v185, v185 row_shr:2 row_mask:0xf bank_mask:0xf bound_ctrl:0
    s_nop 1
    v_max_f32_dpp v185, v185, v185 row_shr:4 row_mask:0xf bank_mask:0xf bound_ctrl:0
    s_nop 1
    v_max_f32_dpp v185, v185, v185 row_shr:8 row_mask:0xf bank_mask:0xf bound_ctrl:0
    s_nop 1
    v_max_f32_dpp v185, v185, v185 row_bcast:15 row_mask:0xa bank_mask:0xf
    s_nop 1
    v_max_f32_dpp v185, v185, v185 row_bcast:31 row_mask:0xc bank_mask:0xf
    v_mov_b32 v184, s6
    s_lshl_b32 s7, s9, 8
    s_add_u32 s7, s7, 9715712
    s_lshl4_add_u32 s8, s4, s5
    s_lshl2_add_u32 s8, s8, s23
    s_lshl_b32 s8, s8, 7
    s_add_u32 s8, s8, 9764864
    s_waitcnt vmcnt(0)
    s_mov_b32 exec_lo, 0
    s_mov_b32 exec_hi, 0x80000000
    buffer_store_dwordx2 v[184:185], off, s[68:71], s7 sc1
    buffer_store_dword v184, off, s[68:71], s8 sc1
    s_mov_b64 exec, -1
    s_lshl1_add_u32 s7, s9, 0
    v_lshlrev_b32 v188, 7, v0
    s_mul_i32 s8, s7, 12544
    buffer_load_dword v189, v188, s[56:59], s8 offen
    s_add_u32 s8, s8, 8192
    s_lshr_b64 exec, -1, 30
    buffer_load_dword v190, v188, s[56:59], s8 offen
    s_mov_b64 exec, -1
    s_barrier
    s_barrier
    v_mov_b32 v179, 0
    ds_read_b64_tr_b16 v[60:61], v12 offset:0
    ds_read_b64_tr_b16 v[62:63], v12 offset:256
    ds_read_b64_tr_b16 v[64:65], v12 offset:4096
    ds_read_b64_tr_b16 v[66:67], v12 offset:4352
    ds_read_b64_tr_b16 v[68:69], v12 offset:8192
    ds_read_b64_tr_b16 v[70:71], v12 offset:8448
    ds_read_b64_tr_b16 v[72:73], v12 offset:12288
    ds_read_b64_tr_b16 v[74:75], v12 offset:12544
    s_waitcnt lgkmcnt(6)
    v_dot2c_f32_bf16 v179, v60, v13
    v_dot2c_f32_bf16 v179, v61, v13
    v_dot2c_f32_bf16 v179, v62, v13
    v_dot2c_f32_bf16 v179, v63, v13
    s_nop 2
    ds_read_b64_tr_b16 v[60:61], v12 offset:16384
    ds_read_b64_tr_b16 v[62:63], v12 offset:16640
    s_waitcnt lgkmcnt(6)
    v_dot2c_f32_bf16 v179, v64, v13
    v_dot2c_f32_bf16 v179, v65, v13
    v_dot2c_f32_bf16 v179, v66, v13
    v_dot2c_f32_bf16 v179, v67, v13
    s_nop 2
    ds_read_b64_tr_b16 v[64:65], v12 offset:20480
    ds_read_b64_tr_b16 v[66:67], v12 offset:20736
    s_waitcnt lgkmcnt(6)
    v_dot2c_f32_bf16 v179, v68, v13
    v_dot2c_f32_bf16 v179, v69, v13
    v_dot2c_f32_bf16 v179, v70, v13
    v_dot2c_f32_bf16 v179, v71, v13
    s_nop 2
    ds_read_b64_tr_b16 v[68:69], v12 offset:24576
    ds_read_b64_tr_b16 v[70:71], v12 offset:24832
    s_waitcnt lgkmcnt(6)
    v_dot2c_f32_bf16 v179, v72, v13
    v_dot2c_f32_bf16 v179, v73, v13
    v_dot2c_f32_bf16 v179, v74, v13
    v_dot2c_f32_bf16 v179, v75, v13
    s_waitcnt lgkmcnt(4)
    v_dot2c_f32_bf16 v179, v60, v13
    v_dot2c_f32_bf16 v179, v61, v13
    v_dot2c_f32_bf16 v179, v62, v13
    v_dot2c_f32_bf16 v179, v63, v13
    s_waitcnt lgkmcnt(2)
    v_dot2c_f32_bf16 v179, v64, v13
    v_dot2c_f32_bf16 v179, v65, v13
    v_dot2c_f32_bf16 v179, v66, v13
    v_dot2c_f32_bf16 v179, v67, v13
    s_waitcnt lgkmcnt(0)
    v_dot2c_f32_bf16 v179, v68, v13
    v_dot2c_f32_bf16 v179, v69, v13
    v_dot2c_f32_bf16 v179, v70, v13
    v_dot2c_f32_bf16 v179, v71, v13
    s_nop 2
    ds_write_b32 v10, v179
    s_waitcnt lgkmcnt(0)
    s_barrier
    s_barrier
    s_lshl1_add_u32 s7, s9, 0
    v_lshlrev_b32 v188, 7, v0
    s_mul_i32 s8, s7, 3200
    s_lshr_b64 exec, -1, 39
    buffer_load_dword v191, v188, s[60:63], s8 offen
    s_mov_b64 exec, -1
    s_waitcnt vmcnt(0)
    s_endpgm
L_sp_v:
    ds_read_b128 v[96:99], v136 offset:0
    ds_read_b64_tr_b16 v[100:101], v144 offset:0
    ds_read_b64_tr_b16 v[102:103], v144 offset:256
    ds_read_b128 v[104:107], v137 offset:0
    ds_read_b64_tr_b16 v[108:109], v144 offset:1024
    ds_read_b64_tr_b16 v[110:111], v144 offset:1280
    ds_read_b128 v[112:115], v138 offset:0
    ds_read_b64_tr_b16 v[116:117], v144 offset:2048
    ds_read_b64_tr_b16 v[118:119], v144 offset:2304
    ds_read_b128 v[120:123], v139 offset:0
    ds_read_b64_tr_b16 v[124:125], v144 offset:3072
    ds_read_b64_tr_b16 v[126:127], v144 offset:3328
    s_waitcnt lgkmcnt(9)
    v_mfma_f32_32x32x16_bf16 v[16:31], v[96:99], v[100:103], 0
    ds_read_b128 v[96:99], v136 offset:8192
    ds_read_b64_tr_b16 v[100:101], v144 offset:8192
    ds_read_b64_tr_b16 v[102:103], v144 offset:8448
    s_waitcnt lgkmcnt(9)
    v_mfma_f32_32x32x16_bf16 v[16:31], v[104:107], v[108:111], v[16:31]
    ds_read_b128 v[104:107], v137 offset:8192
    ds_read_b64_tr_b16 v[108:109], v144 offset:9216
    ds_read_b64_tr_b16 v[110:111], v144 offset:9472
    s_waitcnt lgkmcnt(9)
    v_mfma_f32_32x32x16_bf16 v[16:31], v[112:115], v[116:119], v[16:31]
    ds_read_b128 v[112:115], v138 offset:8192
    ds_read_b64_tr_b16 v[116:117], v144 offset:10240
    ds_read_b64_tr_b16 v[118:119], v144 offset:10496
    s_waitcnt lgkmcnt(9)
    v_mfma_f32_32x32x16_bf16 v[16:31], v[120:123], v[124:127], v[16:31]
    ds_read_b128 v[120:123], v139 offset:8192
    ds_read_b64_tr_b16 v[124:125], v144 offset:11264
    ds_read_b64_tr_b16 v[126:127], v144 offset:11520
    s_waitcnt lgkmcnt(9)
    v_mfma_f32_32x32x16_bf16 v[16:31], v[96:99], v[100:103], v[16:31]
    s_waitcnt lgkmcnt(6)
    v_mfma_f32_32x32x16_bf16 v[16:31], v[104:107], v[108:111], v[16:31]
    s_waitcnt lgkmcnt(3)
    v_mfma_f32_32x32x16_bf16 v[16:31], v[112:115], v[116:119], v[16:31]
    s_waitcnt lgkmcnt(0)
    v_mfma_f32_32x32x16_bf16 v[16:31], v[120:123], v[124:127], v[16:31]
    s_waitcnt vmcnt(1)
    ds_read_b64_tr_b16 v[60:61], v12 offset:16384
    ds_read_b64_tr_b16 v[62:63], v12 offset:16640
    ds_read_b64_tr_b16 v[64:65], v12 offset:20480
    ds_read_b64_tr_b16 v[66:67], v12 offset:20736
    ds_read_b64_tr_b16 v[68:69], v12 offset:24576
    ds_read_b64_tr_b16 v[70:71], v12 offset:24832
    s_waitcnt lgkmcnt(0)
    v_dot2c_f32_bf16 v179, v60, v13
    v_dot2c_f32_bf16 v179, v61, v13
    v_dot2c_f32_bf16 v179, v62, v13
    v_dot2c_f32_bf16 v179, v63, v13
    v_dot2c_f32_bf16 v179, v64, v13
    v_dot2c_f32_bf16 v179, v65, v13
    v_dot2c_f32_bf16 v179, v66, v13
    v_dot2c_f32_bf16 v179, v67, v13
    v_dot2c_f32_bf16 v179, v68, v13
    v_dot2c_f32_bf16 v179, v69, v13
    v_dot2c_f32_bf16 v179, v70, v13
    v_dot2c_f32_bf16 v179, v71, v13
    s_nop 2
    ds_write_b32 v10, v179
    s_waitcnt lgkmcnt(0)
    s_barrier
    s_and_b32 s7, s3, 1
    s_lshl_b32 s7, s7, 7
    s_add_u32 s7, s7, 162816
    v_lshlrev_b32 v184, 2, v0
    v_add_u32 v184, 160768, v184
    v_and_b32 v168, 31, v0
    v_lshl_add_u32 v185, v168, 2, s7
    ds_read2st64_b32 v[32:33], v184 offset0:0 offset1:1
    ds_read2st64_b32 v[34:35], v184 offset0:2 offset1:3
    ds_read_b32 v128, v185
    v_lshrrev_b32 v185, 5, v0
    v_lshl_add_u32 v185, v185, 4, s7
    ds_read_b128 v[64:67], v185 offset:512
    ds_read_b128 v[68:71], v185 offset:544
    ds_read_b128 v[72:75], v185 offset:576
    ds_read_b128 v[76:79], v185 offset:608
    ds_read_b128 v[96:99], v136 offset:16384
    ds_read_b64_tr_b16 v[100:101], v144 offset:16384
    ds_read_b64_tr_b16 v[102:103], v144 offset:16640
    ds_read_b128 v[104:107], v137 offset:16384
    ds_read_b64_tr_b16 v[108:109], v144 offset:17408
    ds_read_b64_tr_b16 v[110:111], v144 offset:17664
    ds_read_b128 v[112:115], v138 offset:16384
    ds_read_b64_tr_b16 v[116:117], v144 offset:18432
    ds_read_b64_tr_b16 v[118:119], v144 offset:18688
    ds_read_b128 v[120:123], v139 offset:16384
    ds_read_b64_tr_b16 v[124:125], v144 offset:19456
    ds_read_b64_tr_b16 v[126:127], v144 offset:19712
    s_waitcnt lgkmcnt(9)
    v_mfma_f32_32x32x16_bf16 v[16:31], v[96:99], v[100:103], v[16:31]
    v_add_f32 v32, v32, v33
    v_add_f32 v34, v34, v35
    v_add_f32 v179, v32, v34
    v_mov_b32 v188, v179
    v_cmp_gt_u32 vcc, 32, v0
    s_nop 0
    v_permlane32_swap_b32 v179, v188
    v_add_f32 v179, v179, v188
    ds_read_b128 v[96:99], v136 offset:24576
    ds_read_b64_tr_b16 v[100:101], v144 offset:24576
    ds_read_b64_tr_b16 v[102:103], v144 offset:24832
    s_waitcnt lgkmcnt(9)
    v_mfma_f32_32x32x16_bf16 v[16:31], v[104:107], v[108:111], v[16:31]
    v_mov_b32 v129, 0
    v_cndmask_b32 v179, 0, v179, vcc
    v_cvt_pk_bf16_f32 v184, v179, v179
    v_and_b32 v184, 0xffff0000, v184
    v_sub_f32 v179, v179, v184
    ds_read_b128 v[104:107], v137 offset:24576
    ds_read_b64_tr_b16 v[108:109], v144 offset:25600
    ds_read_b64_tr_b16 v[110:111], v144 offset:25856
    s_waitcnt lgkmcnt(9)
    v_mfma_f32_32x32x16_bf16 v[16:31], v[112:115], v[116:119], v[16:31]
    v_cvt_pk_bf16_f32 v132, v184, v179
    v_mov_b32 v130, 0
    v_mov_b32 v131, 0
    v_mov_b32 v133, 0
    v_mov_b32 v134, 0
    ds_read_b128 v[112:115], v138 offset:24576
    ds_read_b64_tr_b16 v[116:117], v144 offset:26624
    ds_read_b64_tr_b16 v[118:119], v144 offset:26880
    s_waitcnt lgkmcnt(9)
    v_mfma_f32_32x32x16_bf16 v[16:31], v[120:123], v[124:127], v[16:31]
    v_mov_b32 v135, 0
    v_mov_b32 v169, v168
    v_cmp_le_u32 s[16:17], 10, v168
    s_nop 1
    v_addc_co_u32 v169, s[18:19], 0, v169, s[16:17]
    ds_read_b128 v[120:123], v139 offset:24576
    ds_read_b64_tr_b16 v[124:125], v144 offset:27648
    ds_read_b64_tr_b16 v[126:127], v144 offset:27904
    s_waitcnt lgkmcnt(9)
    v_mfma_f32_32x32x16_bf16 v[16:31], v[96:99], v[100:103], v[16:31]
    v_cmp_le_u32 s[16:17], 13, v168
    s_nop 1
    v_addc_co_u32 v169, s[18:19], 0, v169, s[16:17]
    v_cmp_le_u32 s[16:17], 24, v168
    s_waitcnt lgkmcnt(6)
    v_mfma_f32_32x32x16_bf16 v[16:31], v[104:107], v[108:111], v[16:31]
    s_nop 1
    v_addc_co_u32 v169, s[18:19], 0, v169, s[16:17]
    v_cmp_le_u32 s[16:17], 27, v168
    s_nop 1
    v_addc_co_u32 v169, s[18:19], 0, v169, s[16:17]
    s_waitcnt lgkmcnt(3)
    v_mfma_f32_32x32x16_bf16 v[16:31], v[112:115], v[116:119], v[16:31]
    v_and_b32 v170, 1, v0
    v_lshl_add_u32 v170, v170, 2, 10
    v_and_b32 v171, 2, v0
    v_cmp_le_u32 s[16:17], 28, v168
    v_lshl_add_u32 v170, v171, 3, v170
    s_waitcnt lgkmcnt(0)
    v_mfma_f32_32x32x16_bf16 v[16:31], v[120:123], v[124:127], v[16:31]
    v_and_b32 v171, 32, v0
    v_cndmask_b32 v169, v169, v170, s[16:17]
    v_add_lshl_u32 v169, v169, v171, 4
    s_nop 0
    s_nop 0
    v_mfma_f32_32x32x16_bf16 v[16:31], v[128:131], v[132:135], v[16:31]
    s_barrier
    ds_read_b128 v[48:51], v9 offset:0
    ds_read_b128 v[52:55], v9 offset:1024
    ds_read_b128 v[56:59], v9 offset:2048
    ds_read_b128 v[60:63], v9 offset:3072
    s_nop 6
    v_cmp_gt_u32 vcc, 28, v168
    v_cmp_gt_u32 s[16:17], 30, v168
    v_mov_b32 v187, 0x3f80
    s_lshl_b32 s7, s9, 12
    s_add_u32 s7, s7, 9439232
    v_cndmask_b32 v186, 0, v13, s[16:17]
    s_waitcnt lgkmcnt(2)
    v_add_f32 v16, v16, v48
    v_add_f32 v17, v17, v49
    v_add_f32 v18, v18, v50
    v_add_f32 v19, v19, v51
    v_add_f32 v20, v20, v52
    v_add_f32 v21, v21, v53
    v_add_f32 v22, v22, v54
    v_add_f32 v23, v23, v55
    v_mul_f32 v16, v64, v16
    v_mul_f32 v17, v65, v17
    v_mul_f32 v18, v66, v18
    v_mul_f32 v19, v67, v19
    v_mul_f32 v20, v68, v20
    v_mul_f32 v21, v69, v21
    v_mul_f32 v22, v70, v22
    v_mul_f32 v23, v71, v23
    v_cvt_pk_bf16_f32 v160, v16, v17
    v_cvt_pk_bf16_f32 v161, v18, v19
    v_cvt_pk_bf16_f32 v162, v20, v21
    v_cvt_pk_bf16_f32 v163, v22, v23
    v_cndmask_b32 v160, v186, v160, vcc
    v_cndmask_b32 v161, v186, v161, vcc
    v_cndmask_b32 v162, v186, v162, vcc
    v_cndmask_b32 v163, v186, v163, vcc
    buffer_store_dwordx4 v[160:163], v169, s[68:71], s7 offen offset:0 sc1
    s_waitcnt lgkmcnt(0)
    v_add_f32 v24, v24, v56
    v_add_f32 v25, v25, v57
    v_add_f32 v26, v26, v58
    v_add_f32 v27, v27, v59
    v_add_f32 v28, v28, v60
    v_add_f32 v29, v29, v61
    v_add_f32 v30, v30, v62
    v_add_f32 v31, v31, v63
    v_mul_f32 v24, v72, v24
    v_mul_f32 v25, v73, v25
    v_mul_f32 v26, v74, v26
    v_mul_f32 v27, v75, v27
    v_mul_f32 v28, v76, v28
    v_mul_f32 v29, v77, v29
    v_mul_f32 v30, v78, v30
    v_mul_f32 v31, v79, v31
    v_cvt_pk_bf16_f32 v164, v24, v25
    v_cvt_pk_bf16_f32 v165, v26, v27
    v_cvt_pk_bf16_f32 v166, v28, v29
    v_cvt_pk_bf16_f32 v167, v30, v31
    v_cndmask_b32 v164, v186, v164, vcc
    v_cndmask_b32 v165, v186, v165, vcc
    v_cndmask_b32 v166, v186, v166, vcc
    v_cndmask_b32 v167, v186, v167, vcc
    buffer_store_dwordx4 v[164:167], v169, s[68:71], s7 offen offset:1024 sc1
    v_mov_b32 v185, 0
    v_max3_f32 v185, |v16|, |v17|, v185
    v_max3_f32 v185, |v18|, |v19|, v185
    v_max3_f32 v185, |v20|, |v21|, v185
    v_max3_f32 v185, |v22|, |v23|, v185
    v_max3_f32 v185, |v24|, |v25|, v185
    v_max3_f32 v185, |v26|, |v27|, v185
    v_max3_f32 v185, |v28|, |v29|, v185
    v_max3_f32 v185, |v30|, |v31|, v185
    v_cndmask_b32 v185, 0, v185, vcc
    s_nop 1
    v_max_f32_dpp v185, v185, v185 row_shr:1 row_mask:0xf bank_mask:0xf bound_ctrl:0
    s_nop 1
    v_max_f32_dpp v185, v185, v185 row_shr:2 row_mask:0xf bank_mask:0xf bound_ctrl:0
    s_nop 1
    v_max_f32_dpp v185, v185, v185 row_shr:4 row_mask:0xf bank_mask:0xf bound_ctrl:0
    s_nop 1
    v_max_f32_dpp v185, v185, v185 row_shr:8 row_mask:0xf bank_mask:0xf bound_ctrl:0
    s_nop 1
    v_max_f32_dpp v185, v185, v185 row_bcast:15 row_mask:0xa bank_mask:0xf
    s_nop 1
    v_max_f32_dpp v185, v185, v185 row_bcast:31 row_mask:0xc bank_mask:0xf
    v_mov_b32 v184, s6
    s_lshl_b32 s7, s9, 8
    s_add_u32 s7, s7, 9715840
    s_lshl4_add_u32 s8, s4, s5
    s_lshl2_add_u32 s8, s8, s23
    s_lshl_b32 s8, s8, 7
    s_add_u32 s8, s8, 9764864
    s_waitcnt vmcnt(0)
    s_mov_b32 exec_lo, 0
    s_mov_b32 exec_hi, 0x80000000
    buffer_store_dwordx2 v[184:185], off, s[68:71], s7 sc1
    buffer_store_dword v184, off, s[68:71], s8 sc1
    s_mov_b64 exec, -1
    s_lshl1_add_u32 s7, s9, 1
    v_lshlrev_b32 v188, 7, v0
    s_mul_i32 s8, s7, 12544
    buffer_load_dword v189, v188, s[56:59], s8 offen
    s_add_u32 s8, s8, 8192
    s_lshr_b64 exec, -1, 30
    buffer_load_dword v190, v188, s[56:59], s8 offen
    s_mov_b64 exec, -1
    s_barrier
    s_barrier
    v_mov_b32 v179, 0
    ds_read_b64_tr_b16 v[60:61], v12 offset:0
    ds_read_b64_tr_b16 v[62:63], v12 offset:256
    ds_read_b64_tr_b16 v[64:65], v12 offset:4096
    ds_read_b64_tr_b16 v[66:67], v12 offset:4352
    ds_read_b64_tr_b16 v[68:69], v12 offset:8192
    ds_read_b64_tr_b16 v[70:71], v12 offset:8448
    ds_read_b64_tr_b16 v[72:73], v12 offset:12288
    ds_read_b64_tr_b16 v[74:75], v12 offset:12544
    s_waitcnt lgkmcnt(6)
    v_dot2c_f32_bf16 v179, v60, v13
    v_dot2c_f32_bf16 v179, v61, v13
    v_dot2c_f32_bf16 v179, v62, v13
    v_dot2c_f32_bf16 v179, v63, v13
    s_nop 2
    ds_read_b64_tr_b16 v[60:61], v12 offset:16384
    ds_read_b64_tr_b16 v[62:63], v12 offset:16640
    s_waitcnt lgkmcnt(6)
    v_dot2c_f32_bf16 v179, v64, v13
    v_dot2c_f32_bf16 v179, v65, v13
    v_dot2c_f32_bf16 v179, v66, v13
    v_dot2c_f32_bf16 v179, v67, v13
    s_nop 2
    ds_read_b64_tr_b16 v[64:65], v12 offset:20480
    ds_read_b64_tr_b16 v[66:67], v12 offset:20736
    s_waitcnt lgkmcnt(6)
    v_dot2c_f32_bf16 v179, v68, v13
    v_dot2c_f32_bf16 v179, v69, v13
    v_dot2c_f32_bf16 v179, v70, v13
    v_dot2c_f32_bf16 v179, v71, v13
    s_nop 2
    ds_read_b64_tr_b16 v[68:69], v12 offset:24576
    ds_read_b64_tr_b16 v[70:71], v12 offset:24832
    s_waitcnt lgkmcnt(6)
    v_dot2c_f32_bf16 v179, v72, v13
    v_dot2c_f32_bf16 v179, v73, v13
    v_dot2c_f32_bf16 v179, v74, v13
    v_dot2c_f32_bf16 v179, v75, v13
    s_waitcnt lgkmcnt(4)
    v_dot2c_f32_bf16 v179, v60, v13
    v_dot2c_f32_bf16 v179, v61, v13
    v_dot2c_f32_bf16 v179, v62, v13
    v_dot2c_f32_bf16 v179, v63, v13
    s_waitcnt lgkmcnt(2)
    v_dot2c_f32_bf16 v179, v64, v13
    v_dot2c_f32_bf16 v179, v65, v13
    v_dot2c_f32_bf16 v179, v66, v13
    v_dot2c_f32_bf16 v179, v67, v13
    s_waitcnt lgkmcnt(0)
    v_dot2c_f32_bf16 v179, v68, v13
    v_dot2c_f32_bf16 v179, v69, v13
    v_dot2c_f32_bf16 v179, v70, v13
    v_dot2c_f32_bf16 v179, v71, v13
    s_nop 2
    ds_write_b32 v10, v179
    s_waitcnt lgkmcnt(0)
    s_barrier
    s_barrier
    s_lshl1_add_u32 s7, s9, 1
    v_lshlrev_b32 v188, 7, v0
    s_mul_i32 s8, s7, 3200
    s_lshr_b64 exec, -1, 39
    buffer_load_dword v191, v188, s[60:63], s8 offen
    s_mov_b64 exec, -1
    s_waitcnt vmcnt(0)
    s_cmp_lg_u32 s9, 0
    s_cbranch_scc1 L_fin_prof
    s_mov_b32 s15, 12500
    v_lshlrev_b32 v16, 9, v0
L_keep:
    s_sleep 48
    s_mov_b32 s7, 9764864
    buffer_load_dword v20, v16, s[68:71], s7 offen sc1
    s_mov_b32 s7, 9797632
    buffer_load_dword v21, v16, s[68:71], s7 offen sc1
    s_mov_b32 s7, 9830400
    buffer_load_dword v22, v16, s[68:71], s7 offen sc1
    s_mov_b32 s7, 9863168
    buffer_load_dword v23, v16, s[68:71], s7 offen sc1
    s_waitcnt vmcnt(0)
    v_xor_b32 v60, s6, v20
    v_xor_b32 v61, s6, v21
    v_or_b32 v60, v60, v61
    v_xor_b32 v61, s6, v22
    v_or_b32 v60, v60, v61
    v_xor_b32 v61, s6, v23
    v_or_b32 v60, v60, v61
    v_cmp_eq_u32 vcc, 0, v60
    s_cmp_eq_u64 vcc, -1
    s_cbranch_scc1 L_keep_done
    s_sleep 2
    s_sub_u32 s15, s15, 1
    s_cmp_lg_u32 s15, 0
    s_cbranch_scc1 L_keep
L_keep_done:
    v_mov_b32 v16, s6
    s_mov_b32 s7, 9699328
    s_mov_b64 exec, 1
    buffer_store_dword v16, off, s[68:71], s7 sc1
    s_waitcnt vmcnt(0)
    s_mov_b64 exec, -1
    s_endpgm
L_sp_lo:
    s_bitcmp1_b32 s3, 1
    s_cbranch_scc1 L_sp_lov
    ds_read_b128 v[96:99], v136 offset:4096
    ds_read_b64_tr_b16 v[100:101], v144 offset:4096
    ds_read_b64_tr_b16 v[102:103], v144 offset:4352
    ds_read_b128 v[104:107], v137 offset:4096
    ds_read_b64_tr_b16 v[108:109], v144 offset:5120
    ds_read_b64_tr_b16 v[110:111], v144 offset:5376
    ds_read_b128 v[112:115], v138 offset:4096
    ds_read_b64_tr_b16 v[116:117], v144 offset:6144
    ds_read_b64_tr_b16 v[118:119], v144 offset:6400
    ds_read_b128 v[120:123], v139 offset:4096
    ds_read_b64_tr_b16 v[124:125], v144 offset:7168
    ds_read_b64_tr_b16 v[126:127], v144 offset:7424
    s_waitcnt lgkmcnt(9)
    v_mfma_f32_32x32x16_bf16 v[16:31], v[100:103], v[96:99], 0
    ds_read_b128 v[96:99], v136 offset:12288
    ds_read_b64_tr_b16 v[100:101], v144 offset:12288
    ds_read_b64_tr_b16 v[102:103], v144 offset:12544
    s_waitcnt lgkmcnt(9)
    v_mfma_f32_32x32x16_bf16 v[16:31], v[108:111], v[104:107], v[16:31]
    ds_read_b128 v[104:107], v137 offset:12288
    ds_read_b64_tr_b16 v[108:109], v144 offset:13312
    ds_read_b64_tr_b16 v[110:111], v144 offset:13568
    s_waitcnt lgkmcnt(9)
    v_mfma_f32_32x32x16_bf16 v[16:31], v[116:119], v[112:115], v[16:31]
    ds_read_b128 v[112:115], v138 offset:12288
    ds_read_b64_tr_b16 v[116:117], v144 offset:14336
    ds_read_b64_tr_b16 v[118:119], v144 offset:14592
    s_waitcnt lgkmcnt(9)
    v_mfma_f32_32x32x16_bf16 v[16:31], v[124:127], v[120:123], v[16:31]
    ds_read_b128 v[120:123], v139 offset:12288
    ds_read_b64_tr_b16 v[124:125], v144 offset:15360
    ds_read_b64_tr_b16 v[126:127], v144 offset:15616
    s_waitcnt lgkmcnt(9)
    v_mfma_f32_32x32x16_bf16 v[16:31], v[100:103], v[96:99], v[16:31]
    s_waitcnt lgkmcnt(6)
    v_mfma_f32_32x32x16_bf16 v[16:31], v[108:111], v[104:107], v[16:31]
    s_waitcnt lgkmcnt(3)
    v_mfma_f32_32x32x16_bf16 v[16:31], v[116:119], v[112:115], v[16:31]
    s_waitcnt lgkmcnt(0)
    v_mfma_f32_32x32x16_bf16 v[16:31], v[124:127], v[120:123], v[16:31]
    s_waitcnt vmcnt(1)
    ds_read_b64_tr_b16 v[60:61], v12 offset:16384
    ds_read_b64_tr_b16 v[62:63], v12 offset:16640
    ds_read_b64_tr_b16 v[64:65], v12 offset:20480
    ds_read_b64_tr_b16 v[66:67], v12 offset:20736
    ds_read_b64_tr_b16 v[68:69], v12 offset:24576
    ds_read_b64_tr_b16 v[70:71], v12 offset:24832
    s_waitcnt lgkmcnt(0)
    v_dot2c_f32_bf16 v179, v60, v13
    v_dot2c_f32_bf16 v179, v61, v13
    v_dot2c_f32_bf16 v179, v62, v13
    v_dot2c_f32_bf16 v179, v63, v13
    v_dot2c_f32_bf16 v179, v64, v13
    v_dot2c_f32_bf16 v179, v65, v13
    v_dot2c_f32_bf16 v179, v66, v13
    v_dot2c_f32_bf16 v179, v67, v13
    v_dot2c_f32_bf16 v179, v68, v13
    v_dot2c_f32_bf16 v179, v69, v13
    v_dot2c_f32_bf16 v179, v70, v13
    v_dot2c_f32_bf16 v179, v71, v13
    s_nop 2
    ds_write_b32 v10, v179
    s_waitcnt lgkmcnt(0)
    s_barrier
    ds_read_b128 v[96:99], v136 offset:20480
    ds_read_b64_tr_b16 v[100:101], v144 offset:20480
    ds_read_b64_tr_b16 v[102:103], v144 offset:20736
    ds_read_b128 v[104:107], v137 offset:20480
    ds_read_b64_tr_b16 v[108:109], v144 offset:21504
    ds_read_b64_tr_b16 v[110:111], v144 offset:21760
    ds_read_b128 v[112:115], v138 offset:20480
    ds_read_b64_tr_b16 v[116:117], v144 offset:22528
    ds_read_b64_tr_b16 v[118:119], v144 offset:22784
    ds_read_b128 v[120:123], v139 offset:20480
    ds_read_b64_tr_b16 v[124:125], v144 offset:23552
    ds_read_b64_tr_b16 v[126:127], v144 offset:23808
    s_waitcnt lgkmcnt(9)
    v_mfma_f32_32x32x16_bf16 v[16:31], v[100:103], v[96:99], v[16:31]
    s_waitcnt lgkmcnt(6)
    v_mfma_f32_32x32x16_bf16 v[16:31], v[108:111], v[104:107], v[16:31]
    s_waitcnt lgkmcnt(3)
    v_mfma_f32_32x32x16_bf16 v[16:31], v[116:119], v[112:115], v[16:31]
    s_waitcnt lgkmcnt(0)
    v_mfma_f32_32x32x16_bf16 v[16:31], v[124:127], v[120:123], v[16:31]
    s_branch L_sp_lo2
L_sp_lov:
    ds_read_b128 v[96:99], v136 offset:4096
    ds_read_b64_tr_b16 v[100:101], v144 offset:4096
    ds_read_b64_tr_b16 v[102:103], v144 offset:4352
    ds_read_b128 v[104:107], v137 offset:4096
    ds_read_b64_tr_b16 v[108:109], v144 offset:5120
    ds_read_b64_tr_b16 v[110:111], v144 offset:5376
    ds_read_b128 v[112:115], v138 offset:4096
    ds_read_b64_tr_b16 v[116:117], v144 offset:6144
    ds_read_b64_tr_b16 v[118:119], v144 offset:6400
    ds_read_b128 v[120:123], v139 offset:4096
    ds_read_b64_tr_b16 v[124:125], v144 offset:7168
    ds_read_b64_tr_b16 v[126:127], v144 offset:7424
    s_waitcnt lgkmcnt(9)
    v_mfma_f32_32x32x16_bf16 v[16:31], v[96:99], v[100:103], 0
    ds_read_b128 v[96:99], v136 offset:12288
    ds_read_b64_tr_b16 v[100:101], v144 offset:12288
    ds_read_b64_tr_b16 v[102:103], v144 offset:12544
    s_waitcnt lgkmcnt(9)
    v_mfma_f32_32x32x16_bf16 v[16:31], v[104:107], v[108:111], v[16:31]
    ds_read_b128 v[104:107], v137 offset:12288
    ds_read_b64_tr_b16 v[108:109], v144 offset:13312
    ds_read_b64_tr_b16 v[110:111], v144 offset:13568
    s_waitcnt lgkmcnt(9)
    v_mfma_f32_32x32x16_bf16 v[16:31], v[112:115], v[116:119], v[16:31]
    ds_read_b128 v[112:115], v138 offset:12288
    ds_read_b64_tr_b16 v[116:117], v144 offset:14336
    ds_read_b64_tr_b16 v[118:119], v144 offset:14592
    s_waitcnt lgkmcnt(9)
    v_mfma_f32_32x32x16_bf16 v[16:31], v[120:123], v[124:127], v[16:31]
    ds_read_b128 v[120:123], v139 offset:12288
    ds_read_b64_tr_b16 v[124:125], v144 offset:15360
    ds_read_b64_tr_b16 v[126:127], v144 offset:15616
    s_waitcnt lgkmcnt(9)
    v_mfma_f32_32x32x16_bf16 v[16:31], v[96:99], v[100:103], v[16:31]
    s_waitcnt lgkmcnt(6)
    v_mfma_f32_32x32x16_bf16 v[16:31], v[104:107], v[108:111], v[16:31]
    s_waitcnt lgkmcnt(3)
    v_mfma_f32_32x32x16_bf16 v[16:31], v[112:115], v[116:119], v[16:31]
    s_waitcnt lgkmcnt(0)
    v_mfma_f32_32x32x16_bf16 v[16:31], v[120:123], v[124:127], v[16:31]
    s_waitcnt vmcnt(1)
    ds_read_b64_tr_b16 v[60:61], v12 offset:16384
    ds_read_b64_tr_b16 v[62:63], v12 offset:16640
    ds_read_b64_tr_b16 v[64:65], v12 offset:20480
    ds_read_b64_tr_b16 v[66:67], v12 offset:20736
    ds_read_b64_tr_b16 v[68:69], v12 offset:24576
    ds_read_b64_tr_b16 v[70:71], v12 offset:24832
    s_waitcnt lgkmcnt(0)
    v_dot2c_f32_bf16 v179, v60, v13
    v_dot2c_f32_bf16 v179, v61, v13
    v_dot2c_f32_bf16 v179, v62, v13
    v_dot2c_f32_bf16 v179, v63, v13
    v_dot2c_f32_bf16 v179, v64, v13
    v_dot2c_f32_bf16 v179, v65, v13
    v_dot2c_f32_bf16 v179, v66, v13
    v_dot2c_f32_bf16 v179, v67, v13
    v_dot2c_f32_bf16 v179, v68, v13
    v_dot2c_f32_bf16 v179, v69, v13
    v_dot2c_f32_bf16 v179, v70, v13
    v_dot2c_f32_bf16 v179, v71, v13
    s_nop 2
    ds_write_b32 v10, v179
    s_waitcnt lgkmcnt(0)
    s_barrier
    ds_read_b128 v[96:99], v136 offset:20480
    ds_read_b64_tr_b16 v[100:101], v144 offset:20480
    ds_read_b64_tr_b16 v[102:103], v144 offset:20736
    ds_read_b128 v[104:107], v137 offset:20480
    ds_read_b64_tr_b16 v[108:109], v144 offset:21504
    ds_read_b64_tr_b16 v[110:111], v144 offset:21760
    ds_read_b128 v[112:115], v138 offset:20480
    ds_read_b64_tr_b16 v[116:117], v144 offset:22528
    ds_read_b64_tr_b16 v[118:119], v144 offset:22784
    ds_read_b128 v[120:123], v139 offset:20480
    ds_read_b64_tr_b16 v[124:125], v144 offset:23552
    ds_read_b64_tr_b16 v[126:127], v144 offset:23808
    s_waitcnt lgkmcnt(9)
    v_mfma_f32_32x32x16_bf16 v[16:31], v[96:99], v[100:103], v[16:31]
    s_waitcnt lgkmcnt(6)
    v_mfma_f32_32x32x16_bf16 v[16:31], v[104:107], v[108:111], v[16:31]
    s_waitcnt lgkmcnt(3)
    v_mfma_f32_32x32x16_bf16 v[16:31], v[112:115], v[116:119], v[16:31]
    s_waitcnt lgkmcnt(0)
    v_mfma_f32_32x32x16_bf16 v[16:31], v[120:123], v[124:127], v[16:31]
L_sp_lo2:
    s_lshr_b32 s7, s80, 1
    s_xor_b32 s7, s7, 1
    s_lshl3_add_u32 s7, s7, s3
    s_lshl_b32 s7, s7, 3
    v_lshrrev_b32 v11, 3, v0
    v_add_u32 v11, s7, v11
    v_bfe_u32 v10, v11, 1, 3
    v_mul_u32_u24 v11, 896, v11
    v_and_b32 v12, 7, v0
    v_xor_b32 v12, v12, v10
    v_lshl_add_u32 v3, v12, 4, v11
    s_nop 0
    ds_write_b128 v9, v[16:19] offset:0
    ds_write_b128 v9, v[20:23] offset:1024
    ds_write_b128 v9, v[24:27] offset:2048
    ds_write_b128 v9, v[28:31] offset:3072
    s_waitcnt lgkmcnt(0)
    s_barrier
    s_add_u32 m0, s13, 114688
    s_lshl_b32 s7, s82, 7
    buffer_load_dwordx4 v3, s[40:43], s7 offen lds
    s_add_u32 s82, s82, 1
    s_cmp_eq_u32 s82, 7
    s_cselect_b32 s82, 0, s82
    s_add_u32 m0, s13, 118784
    s_lshl_b32 s7, s82, 7
    buffer_load_dwordx4 v3, s[40:43], s7 offen lds
    s_add_u32 s82, s82, 1
    s_cmp_eq_u32 s82, 7
    s_cselect_b32 s82, 0, s82
    s_add_u32 m0, s13, 122880
    s_lshl_b32 s7, s82, 7
    buffer_load_dwordx4 v3, s[40:43], s7 offen lds
    s_add_u32 s82, s82, 1
    s_cmp_eq_u32 s82, 7
    s_cselect_b32 s82, 0, s82
    s_add_u32 m0, s13, 126976
    s_lshl_b32 s7, s82, 7
    buffer_load_dwordx4 v3, s[40:43], s7 offen lds
    s_add_u32 s82, s82, 1
    s_cmp_eq_u32 s82, 7
    s_cselect_b32 s82, 0, s82
    s_add_u32 m0, s13, 131072
    s_lshl_b32 s7, s82, 7
    buffer_load_dwordx4 v3, s[40:43], s7 offen lds
    s_add_u32 s82, s82, 1
    s_cmp_eq_u32 s82, 7
    s_cselect_b32 s82, 0, s82
    s_add_u32 m0, s13, 135168
    s_lshl_b32 s7, s82, 7
    buffer_load_dwordx4 v3, s[40:43], s7 offen lds
    s_add_u32 s82, s82, 1
    s_cmp_eq_u32 s82, 7
    s_cselect_b32 s82, 0, s82
    s_add_u32 m0, s13, 139264
    s_lshl_b32 s7, s82, 7
    buffer_load_dwordx4 v3, s[40:43], s7 offen lds
    s_add_u32 s82, s82, 1
    s_cmp_eq_u32 s82, 7
    s_cselect_b32 s82, 0, s82
    s_bitcmp1_b32 s3, 0
    s_cselect_b32 s7, 1, 2
    s_mul_i32 s7, s7, 57344
    s_lshr_b32 s8, s3, 1
    s_xor_b32 s8, s8, s5
    s_bitcmp1_b32 s8, 0
    s_cselect_b32 s7, s7, s14
    v_add_u32 v136, s7, v140
    v_xor_b32 v137, 32, v136
    v_xor_b32 v138, 64, v136
    v_xor_b32 v139, 96, v136
    v_add_u32 v144, 86016, v145
    s_barrier
    s_add_u32 m0, s13, 57344
    s_lshl_b32 s7, s82, 7
    s_add_u32 s7, s7, 28672
    buffer_load_dwordx4 v3, s[40:43], s7 offen lds
    s_add_u32 m0, s13, 86016
    s_mul_i32 s7, s82, 57344
    buffer_load_dwordx4 v6, s[44:47], s7 offen lds
    s_add_u32 s82, s82, 1
    s_cmp_eq_u32 s82, 7
    s_cselect_b32 s82, 0, s82
    s_add_u32 m0, s13, 61440
    s_lshl_b32 s7, s82, 7
    s_add_u32 s7, s7, 28672
    buffer_load_dwordx4 v3, s[40:43], s7 offen lds
    s_add_u32 m0, s13, 90112
    s_mul_i32 s7, s82, 57344
    buffer_load_dwordx4 v6, s[44:47], s7 offen lds
    s_add_u32 s82, s82, 1
    s_cmp_eq_u32 s82, 7
    s_cselect_b32 s82, 0, s82
    s_add_u32 m0, s13, 65536
    s_lshl_b32 s7, s82, 7
    s_add_u32 s7, s7, 28672
    buffer_load_dwordx4 v3, s[40:43], s7 offen lds
    s_add_u32 m0, s13, 94208
    s_mul_i32 s7, s82, 57344
    buffer_load_dwordx4 v6, s[44:47], s7 offen lds
    s_add_u32 s82, s82, 1
    s_cmp_eq_u32 s82, 7
    s_cselect_b32 s82, 0, s82
    s_add_u32 m0, s13, 69632
    s_lshl_b32 s7, s82, 7
    s_add_u32 s7, s7, 28672
    buffer_load_dwordx4 v3, s[40:43], s7 offen lds
    s_add_u32 m0, s13, 98304
    s_mul_i32 s7, s82, 57344
    buffer_load_dwordx4 v6, s[44:47], s7 offen lds
    s_add_u32 s82, s82, 1
    s_cmp_eq_u32 s82, 7
    s_cselect_b32 s82, 0, s82
    s_add_u32 m0, s13, 73728
    s_lshl_b32 s7, s82, 7
    s_add_u32 s7, s7, 28672
    buffer_load_dwordx4 v3, s[40:43], s7 offen lds
    s_add_u32 m0, s13, 102400
    s_mul_i32 s7, s82, 57344
    buffer_load_dwordx4 v6, s[44:47], s7 offen lds
    s_add_u32 s82, s82, 1
    s_cmp_eq_u32 s82, 7
    s_cselect_b32 s82, 0, s82
    s_add_u32 m0, s13, 77824
    s_lshl_b32 s7, s82, 7
    s_add_u32 s7, s7, 28672
    buffer_load_dwordx4 v3, s[40:43], s7 offen lds
    s_add_u32 m0, s13, 106496
    s_mul_i32 s7, s82, 57344
    buffer_load_dwordx4 v6, s[44:47], s7 offen lds
    s_add_u32 s82, s82, 1
    s_cmp_eq_u32 s82, 7
    s_cselect_b32 s82, 0, s82
    s_add_u32 m0, s13, 81920
    s_lshl_b32 s7, s82, 7
    s_add_u32 s7, s7, 28672
    buffer_load_dwordx4 v3, s[40:43], s7 offen lds
    s_add_u32 m0, s13, 110592
    s_mul_i32 s7, s82, 57344
    buffer_load_dwordx4 v6, s[44:47], s7 offen lds
    s_add_u32 s82, s82, 1
    s_cmp_eq_u32 s82, 7
    s_cselect_b32 s82, 0, s82
    v_and_b32 v10, 31, v0
    v_lshlrev_b32 v10, 4, v10
    v_lshlrev_b32 v11, 8, v0
    s_lshl2_add_u32 s82, s4, s3
    s_lshl_b32 s82, s82, 9
    s_add_u32 s82, s82, 9732096
    s_mov_b32 s81, 9715712
    buffer_load_dwordx3 v[128:130], v10, s[68:71], s82 offen sc1
    buffer_load_dwordx2 v[248:249], v11, s[68:71], s81 offen sc1
    buffer_load_dwordx2 v[250:251], v11, s[68:71], s81 offen offset:128 sc1
    s_lshl_b32 s79, s23, 16
    s_add_u32 s79, s79, 9433088
    s_add_u32 s72, s68, s79
    s_addc_u32 s73, s69, 0
    s_mov_b32 s74, 4096
    s_mov_b32 s75, 0x20000
    v_mov_b32 v179, 0
    v_and_b32 v9, 3, v0
    v_lshl_add_u32 v9, v9, 2, s77
    v_lshlrev_b32 v12, 2, v0
    v_add_u32 v12, 160768, v12
    s_waitcnt vmcnt(3)
    s_barrier
    ds_write_b32 v9, v179
    ds_read_b128 v[96:99], v136 offset:0
    ds_read_b64_tr_b16 v[100:101], v144 offset:0
    ds_read_b64_tr_b16 v[102:103], v144 offset:256
    ds_read_b128 v[104:107], v137 offset:0
    ds_read_b64_tr_b16 v[108:109], v144 offset:1024
    ds_read_b64_tr_b16 v[110:111], v144 offset:1280
    ds_read_b128 v[112:115], v138 offset:0
    ds_read_b64_tr_b16 v[116:117], v144 offset:2048
    ds_read_b64_tr_b16 v[118:119], v144 offset:2304
    ds_read_b128 v[120:123], v139 offset:0
    ds_read_b64_tr_b16 v[124:125], v144 offset:3072
    ds_read_b64_tr_b16 v[126:127], v144 offset:3328
    s_waitcnt lgkmcnt(9)
    v_mfma_f32_32x32x16_bf16 v[16:31], v[100:103], v[96:99], 0
    ds_read_b128 v[96:99], v136 offset:4096
    ds_read_b64_tr_b16 v[100:101], v144 offset:4096
    ds_read_b64_tr_b16 v[102:103], v144 offset:4352
    s_waitcnt lgkmcnt(9)
    v_mfma_f32_32x32x16_bf16 v[16:31], v[108:111], v[104:107], v[16:31]
    ds_read_b128 v[104:107], v137 offset:4096
    ds_read_b64_tr_b16 v[108:109], v144 offset:5120
    ds_read_b64_tr_b16 v[110:111], v144 offset:5376
    s_waitcnt lgkmcnt(9)
    v_mfma_f32_32x32x16_bf16 v[16:31], v[116:119], v[112:115], v[16:31]
    s_waitcnt lgkmcnt(6)
    v_mfma_f32_32x32x16_bf16 v[16:31], v[124:127], v[120:123], v[16:31]
    s_waitcnt lgkmcnt(3)
    v_mfma_f32_32x32x16_bf16 v[16:31], v[100:103], v[96:99], v[16:31]
    s_waitcnt lgkmcnt(0)
    v_mfma_f32_32x32x16_bf16 v[16:31], v[108:111], v[104:107], v[16:31]
    s_waitcnt vmcnt(0)
    v_cmp_eq_u32 s[16:17], s6, v130
    v_cmp_eq_u32 s[18:19], s6, v248
    v_cmp_eq_u32 vcc, s6, v250
    s_and_b64 s[16:17], s[16:17], s[18:19]
    s_and_b64 s[16:17], s[16:17], vcc
    s_cmp_eq_u64 s[16:17], -1
    s_cbranch_scc0 L_kvretrys
L_kvoks:
    ds_read_b128 v[96:99], v138 offset:4096
    ds_read_b64_tr_b16 v[100:101], v144 offset:6144
    ds_read_b64_tr_b16 v[102:103], v144 offset:6400
    ds_read_b128 v[104:107], v139 offset:4096
    ds_read_b64_tr_b16 v[108:109], v144 offset:7168
    ds_read_b64_tr_b16 v[110:111], v144 offset:7424
    ds_read_b128 v[112:115], v136 offset:8192
    ds_read_b64_tr_b16 v[116:117], v144 offset:8192
    ds_read_b64_tr_b16 v[118:119], v144 offset:8448
    ds_read_b128 v[120:123], v137 offset:8192
    ds_read_b64_tr_b16 v[124:125], v144 offset:9216
    ds_read_b64_tr_b16 v[126:127], v144 offset:9472
    s_waitcnt lgkmcnt(9)
    v_mfma_f32_32x32x16_bf16 v[16:31], v[100:103], v[96:99], v[16:31]
    s_add_u32 s72, s72, 4096
    s_addc_u32 s73, s73, 0
    ds_read_b128 v[96:99], v138 offset:8192
    ds_read_b64_tr_b16 v[100:101], v144 offset:10240
    ds_read_b64_tr_b16 v[102:103], v144 offset:10496
    s_waitcnt lgkmcnt(9)
    v_mfma_f32_32x32x16_bf16 v[16:31], v[108:111], v[104:107], v[16:31]
    buffer_load_dwordx4 v[192:195], v8, s[72:75], 0 offen offset:0 sc1
    buffer_load_dwordx4 v[196:199], v8, s[72:75], 0 offen offset:1024 sc1
    ds_read_b128 v[104:107], v139 offset:8192
    ds_read_b64_tr_b16 v[108:109], v144 offset:11264
    ds_read_b64_tr_b16 v[110:111], v144 offset:11520
    s_waitcnt lgkmcnt(9)
    v_mfma_f32_32x32x16_bf16 v[16:31], v[116:119], v[112:115], v[16:31]
    buffer_load_dwordx4 v[200:203], v8, s[72:75], 0 offen offset:2048 sc1
    buffer_load_dwordx4 v[204:207], v8, s[72:75], 0 offen offset:3072 sc1
    ds_read_b128 v[112:115], v136 offset:12288
    ds_read_b64_tr_b16 v[116:117], v144 offset:12288
    ds_read_b64_tr_b16 v[118:119], v144 offset:12544
    s_waitcnt lgkmcnt(9)
    v_mfma_f32_32x32x16_bf16 v[16:31], v[124:127], v[120:123], v[16:31]
    s_add_u32 s72, s72, 4096
    s_addc_u32 s73, s73, 0
    ds_read_b128 v[120:123], v137 offset:12288
    ds_read_b64_tr_b16 v[124:125], v144 offset:13312
    ds_read_b64_tr_b16 v[126:127], v144 offset:13568
    s_waitcnt lgkmcnt(9)
    v_mfma_f32_32x32x16_bf16 v[16:31], v[100:103], v[96:99], v[16:31]
    buffer_load_dwordx4 v[208:211], v8, s[72:75], 0 offen offset:0 sc1
    buffer_load_dwordx4 v[212:215], v8, s[72:75], 0 offen offset:1024 sc1
    ds_read_b128 v[96:99], v138 offset:12288
    ds_read_b64_tr_b16 v[100:101], v144 offset:14336
    ds_read_b64_tr_b16 v[102:103], v144 offset:14592
    s_waitcnt lgkmcnt(9)
    v_mfma_f32_32x32x16_bf16 v[16:31], v[108:111], v[104:107], v[16:31]
    buffer_load_dwordx4 v[216:219], v8, s[72:75], 0 offen offset:2048 sc1
    buffer_load_dwordx4 v[220:223], v8, s[72:75], 0 offen offset:3072 sc1
    ds_read_b128 v[104:107], v139 offset:12288
    ds_read_b64_tr_b16 v[108:109], v144 offset:15360
    ds_read_b64_tr_b16 v[110:111], v144 offset:15616
    s_waitcnt lgkmcnt(9)
    v_mfma_f32_32x32x16_bf16 v[16:31], v[116:119], v[112:115], v[16:31]
    s_add_u32 s72, s72, 4096
    s_addc_u32 s73, s73, 0
    ds_read_b128 v[112:115], v136 offset:16384
    ds_read_b64_tr_b16 v[116:117], v144 offset:16384
    ds_read_b64_tr_b16 v[118:119], v144 offset:16640
    s_waitcnt lgkmcnt(9)
    v_mfma_f32_32x32x16_bf16 v[16:31], v[124:127], v[120:123], v[16:31]
    buffer_load_dwordx4 v[224:227], v8, s[72:75], 0 offen offset:0 sc1
    buffer_load_dwordx4 v[228:231], v8, s[72:75], 0 offen offset:1024 sc1
    ds_read_b128 v[120:123], v137 offset:16384
    ds_read_b64_tr_b16 v[124:125], v144 offset:17408
    ds_read_b64_tr_b16 v[126:127], v144 offset:17664
    s_waitcnt lgkmcnt(9)
    v_mfma_f32_32x32x16_bf16 v[16:31], v[100:103], v[96:99], v[16:31]
    buffer_load_dwordx4 v[232:235], v8, s[72:75], 0 offen offset:2048 sc1
    buffer_load_dwordx4 v[236:239], v8, s[72:75], 0 offen offset:3072 sc1
    ds_read_b128 v[96:99], v138 offset:16384
    ds_read_b64_tr_b16 v[100:101], v144 offset:18432
    ds_read_b64_tr_b16 v[102:103], v144 offset:18688
    s_waitcnt lgkmcnt(9)
    v_mfma_f32_32x32x16_bf16 v[16:31], v[108:111], v[104:107], v[16:31]
    s_nop 0
    v_max_f32_dpp v249, v249, v249 row_shr:1 row_mask:0xf bank_mask:0xf bound_ctrl:0
    ds_read_b128 v[104:107], v139 offset:16384
    ds_read_b64_tr_b16 v[108:109], v144 offset:19456
    ds_read_b64_tr_b16 v[110:111], v144 offset:19712
    s_waitcnt lgkmcnt(9)
    v_mfma_f32_32x32x16_bf16 v[16:31], v[116:119], v[112:115], v[16:31]
    v_max_f32_dpp v251, v251, v251 row_shr:1 row_mask:0xf bank_mask:0xf bound_ctrl:0
    s_nop 0
    ds_read_b128 v[112:115], v136 offset:20480
    ds_read_b64_tr_b16 v[116:117], v144 offset:20480
    ds_read_b64_tr_b16 v[118:119], v144 offset:20736
    s_waitcnt lgkmcnt(9)
    v_mfma_f32_32x32x16_bf16 v[16:31], v[124:127], v[120:123], v[16:31]
    v_max_f32_dpp v249, v249, v249 row_shr:2 row_mask:0xf bank_mask:0xf bound_ctrl:0
    v_max_f32_dpp v251, v251, v251 row_shr:2 row_mask:0xf bank_mask:0xf bound_ctrl:0
    ds_read_b128 v[120:123], v137 offset:20480
    ds_read_b64_tr_b16 v[124:125], v144 offset:21504
    ds_read_b64_tr_b16 v[126:127], v144 offset:21760
    s_waitcnt lgkmcnt(9)
    v_mfma_f32_32x32x16_bf16 v[16:31], v[100:103], v[96:99], v[16:31]
    s_nop 0
    v_max_f32_dpp v249, v249, v249 row_shr:4 row_mask:0xf bank_mask:0xf bound_ctrl:0
    ds_read_b128 v[96:99], v138 offset:20480
    ds_read_b64_tr_b16 v[100:101], v144 offset:22528
    ds_read_b64_tr_b16 v[102:103], v144 offset:22784
    s_waitcnt lgkmcnt(9)
    v_mfma_f32_32x32x16_bf16 v[16:31], v[108:111], v[104:107], v[16:31]
    v_max_f32_dpp v251, v251, v251 row_shr:4 row_mask:0xf bank_mask:0xf bound_ctrl:0
    s_nop 0
    ds_read_b128 v[104:107], v139 offset:20480
    ds_read_b64_tr_b16 v[108:109], v144 offset:23552
    ds_read_b64_tr_b16 v[110:111], v144 offset:23808
    s_waitcnt lgkmcnt(9)
    v_mfma_f32_32x32x16_bf16 v[16:31], v[116:119], v[112:115], v[16:31]
    v_max_f32_dpp v249, v249, v249 row_shr:8 row_mask:0xf bank_mask:0xf bound_ctrl:0
    v_max_f32_dpp v251, v251, v251 row_shr:8 row_mask:0xf bank_mask:0xf bound_ctrl:0
    ds_read_b128 v[112:115], v136 offset:24576
    ds_read_b64_tr_b16 v[116:117], v144 offset:24576
    ds_read_b64_tr_b16 v[118:119], v144 offset:24832
    s_waitcnt lgkmcnt(9)
    v_mfma_f32_32x32x16_bf16 v[16:31], v[124:127], v[120:123], v[16:31]
    s_nop 0
    v_max_f32_dpp v249, v249, v249 row_bcast:15 row_mask:0xa bank_mask:0xf
    ds_read_b128 v[120:123], v137 offset:24576
    ds_read_b64_tr_b16 v[124:125], v144 offset:25600
    ds_read_b64_tr_b16 v[126:127], v144 offset:25856
    s_waitcnt lgkmcnt(9)
    v_mfma_f32_32x32x16_bf16 v[16:31], v[100:103], v[96:99], v[16:31]
    v_max_f32_dpp v251, v251, v251 row_bcast:15 row_mask:0xa bank_mask:0xf
    s_nop 0
    ds_read_b128 v[96:99], v138 offset:24576
    ds_read_b64_tr_b16 v[100:101], v144 offset:26624
    ds_read_b64_tr_b16 v[102:103], v144 offset:26880
    s_waitcnt lgkmcnt(9)
    v_mfma_f32_32x32x16_bf16 v[16:31], v[108:111], v[104:107], v[16:31]
    v_max_f32_dpp v249, v249, v249 row_bcast:31 row_mask:0xc bank_mask:0xf
    v_max_f32_dpp v251, v251, v251 row_bcast:31 row_mask:0xc bank_mask:0xf
    ds_read_b128 v[104:107], v139 offset:24576
    ds_read_b64_tr_b16 v[108:109], v144 offset:27648
    ds_read_b64_tr_b16 v[110:111], v144 offset:27904
    s_waitcnt lgkmcnt(9)
    v_mfma_f32_32x32x16_bf16 v[16:31], v[116:119], v[112:115], v[16:31]
    s_nop 0
    v_readlane_b32 s93, v249, 63
    s_waitcnt lgkmcnt(6)
    v_mfma_f32_32x32x16_bf16 v[16:31], v[124:127], v[120:123], v[16:31]
    v_readlane_b32 s94, v251, 63
    s_add_u32 s72, s72, 4096
    s_waitcnt lgkmcnt(3)
    v_mfma_f32_32x32x16_bf16 v[16:31], v[100:103], v[96:99], v[16:31]
    s_addc_u32 s73, s73, 0
    buffer_load_dwordx4 v[240:243], v8, s[72:75], 0 offen offset:0 sc1
    s_waitcnt lgkmcnt(0)
    v_mfma_f32_32x32x16_bf16 v[16:31], v[108:111], v[104:107], v[16:31]
    buffer_load_dwordx4 v[244:247], v8, s[72:75], 0 offen offset:1024 sc1
    buffer_load_dwordx4 v[248:251], v8, s[72:75], 0 offen offset:2048 sc1
    buffer_load_dwordx4 v[252:255], v8, s[72:75], 0 offen offset:3072 sc1
    s_barrier
    ds_read2st64_b32 v[32:33], v12 offset0:0 offset1:1
    ds_read2st64_b32 v[34:35], v12 offset0:2 offset1:3
    s_waitcnt lgkmcnt(0)
    v_add_f32 v32, v32, v33
    v_add_f32 v34, v34, v35
    v_add_f32 v179, v32, v34
    v_mov_b32 v188, v179
    v_cmp_gt_u32 vcc, 32, v0
    s_nop 0
    v_permlane32_swap_b32 v179, v188
    v_add_f32 v179, v179, v188
    v_cmp_gt_u32 vcc, 32, v0
    v_mul_f32 v186, 0x3e8b97f6, v129
    s_nop 0
    v_cndmask_b32 v187, 0, v186, vcc
    v_mul_f32 v14, v129, v129
    v_cndmask_b32 v179, 0, v179, vcc
    v_cvt_pk_bf16_f32 v184, v179, v179
    v_and_b32 v184, 0xffff0000, v184
    v_sub_f32 v179, v179, v184
    v_cvt_pk_bf16_f32 v132, v184, v179
    v_rcp_f32 v14, v14
    v_mov_b32 v129, 0
    v_mov_b32 v130, 0
    v_mov_b32 v131, 0
    v_mov_b32 v133, 0
    v_mov_b32 v134, 0
    v_mov_b32 v135, 0
    s_nop 1
    v_mfma_f32_32x32x16_bf16 v[16:31], v[132:135], v[128:131], v[16:31]
    s_nop 8
    s_lshl_b32 s7, s23, 11
    s_add_u32 s8, s7, s76
    v_add_u32 v168, s8, v8
    v_mul_f32 v16, v186, v16
    v_mul_f32 v17, v186, v17
    v_mul_f32 v18, v186, v18
    v_mul_f32 v19, v186, v19
    v_mul_f32 v20, v186, v20
    v_mul_f32 v21, v186, v21
    v_mul_f32 v22, v186, v22
    v_mul_f32 v23, v186, v23
    v_cvt_pk_bf16_f32 v160, v16, v17
    v_cvt_pk_bf16_f32 v161, v18, v19
    v_cvt_pk_bf16_f32 v162, v20, v21
    v_cvt_pk_bf16_f32 v163, v22, v23
    ds_write_b128 v168, v[160:163] offset:0
    v_mul_f32 v24, v186, v24
    v_mul_f32 v25, v186, v25
    v_mul_f32 v26, v186, v26
    v_mul_f32 v27, v186, v27
    v_mul_f32 v28, v187, v28
    v_mul_f32 v29, v187, v29
    v_mul_f32 v30, v187, v30
    v_mul_f32 v31, v187, v31
    v_cvt_pk_bf16_f32 v164, v24, v25
    v_cvt_pk_bf16_f32 v165, v26, v27
    v_cvt_pk_bf16_f32 v166, v28, v29
    v_cvt_pk_bf16_f32 v167, v30, v31
    ds_write_b128 v168, v[164:167] offset:1024
    v_mul_f32 v169, v16, v16
    v_mul_f32 v170, v17, v17
    v_fmac_f32 v169, v18, v18
    v_fmac_f32 v170, v19, v19
    v_fmac_f32 v169, v20, v20
    v_fmac_f32 v170, v21, v21
    v_fmac_f32 v169, v22, v22
    v_fmac_f32 v170, v23, v23
    v_fmac_f32 v169, v24, v24
    v_fmac_f32 v170, v25, v25
    v_fmac_f32 v169, v26, v26
    v_fmac_f32 v170, v27, v27
    v_fmac_f32 v169, v28, v28
    v_fmac_f32 v170, v29, v29
    v_fmac_f32 v169, v30, v30
    v_fmac_f32 v170, v31, v31
    v_add_f32 v169, v169, v170
    s_lshl2_add_u32 s8, s23, s76
    v_mov_b32 v170, v169
    v_mov_b32 v168, s8
    s_nop 0
    v_permlane32_swap_b32 v169, v170
    v_add_f32 v169, v169, v170
    v_mul_f32 v169, s93, v169
    v_cmp_ge_f32 vcc, 0x45610000, v169
    s_cmp_eq_u64 vcc, -1
    s_cselect_b32 s7, 0, 1
    s_cmp_le_u32 s94, 0x58800000
    s_cselect_b32 s7, s7, 1
    v_mov_b32 v169, s7
    ds_write_b32 v168, v169 offset:10240
    s_waitcnt lgkmcnt(0)
    s_mov_b32 s90, 0
    s_barrier
    s_branch L_attn
L_slow:
    v_mov_b32 v168, 0xff800000
    v_mov_b32 v169, 0xff800000
    v_mov_b32 v170, 0xff800000
    v_mov_b32 v171, 0xff800000
    s_mov_b32 s8, 9437184
    s_mov_b32 s78, 64
L_slow_loop:
    buffer_load_dwordx4 v[176:179], v8, s[68:71], s8 offen sc1
    buffer_load_dwordx4 v[180:183], v8, s[68:71], s8 offen offset:1024 sc1
    s_waitcnt vmcnt(0)
    v_mfma_f32_32x32x16_bf16 v[112:127], v[176:179], v[16:19], 0
    v_mfma_f32_32x32x16_bf16 v[112:127], v[180:183], v[20:23], v[112:127]
    s_nop 11
    v_max3_f32 v168, v112, v113, v168
    v_max3_f32 v168, v114, v115, v168
    v_max3_f32 v168, v116, v117, v168
    v_max3_f32 v168, v118, v119, v168
    v_max3_f32 v168, v120, v121, v168
    v_max3_f32 v168, v122, v123, v168
    v_max3_f32 v168, v124, v125, v168
    v_max3_f32 v168, v126, v127, v168
    v_mfma_f32_32x32x16_bf16 v[112:127], v[176:179], v[24:27], 0
    v_mfma_f32_32x32x16_bf16 v[112:127], v[180:183], v[28:31], v[112:127]
    s_nop 11
    v_max3_f32 v169, v112, v113, v169
    v_max3_f32 v169, v114, v115, v169
    v_max3_f32 v169, v116, v117, v169
    v_max3_f32 v169, v118, v119, v169
    v_max3_f32 v169, v120, v121, v169
    v_max3_f32 v169, v122, v123, v169
    v_max3_f32 v169, v124, v125, v169
    v_max3_f32 v169, v126, v127, v169
    v_mfma_f32_32x32x16_bf16 v[112:127], v[176:179], v[32:35], 0
    v_mfma_f32_32x32x16_bf16 v[112:127], v[180:183], v[36:39], v[112:127]
    s_nop 11
    v_max3_f32 v170, v112, v113, v170
    v_max3_f32 v170, v114, v115, v170
    v_max3_f32 v170, v116, v117, v170
    v_max3_f32 v170, v118, v119, v170
    v_max3_f32 v170, v120, v121, v170
    v_max3_f32 v170, v122, v123, v170
    v_max3_f32 v170, v124, v125, v170
    v_max3_f32 v170, v126, v127, v170
    v_mfma_f32_32x32x16_bf16 v[112:127], v[176:179], v[40:43], 0
    v_mfma_f32_32x32x16_bf16 v[112:127], v[180:183], v[44:47], v[112:127]
    s_nop 11
    v_max3_f32 v171, v112, v113, v171
    v_max3_f32 v171, v114, v115, v171
    v_max3_f32 v171, v116, v117, v171
    v_max3_f32 v171, v118, v119, v171
    v_max3_f32 v171, v120, v121, v171
    v_max3_f32 v171, v122, v123, v171
    v_max3_f32 v171, v124, v125, v171
    v_max3_f32 v171, v126, v127, v171
    s_add_u32 s8, s8, 4096
    s_sub_u32 s78, s78, 1
    s_cmp_lg_u32 s78, 0
    s_cbranch_scc1 L_slow_loop
    v_cmp_gt_u32 vcc, 32, v0
    v_mov_b32 v176, v168
    s_nop 1
    v_permlane32_swap_b32 v168, v176
    v_max_f32 v176, v168, v176
    v_sub_f32 v176, 0, v176
    v_cvt_pk_bf16_f32 v177, v176, v176
    v_and_b32 v177, 0xffff0000, v177
    v_sub_f32 v176, v176, v177
    v_cvt_pk_bf16_f32 v178, v176, v176
    v_and_b32 v178, 0xffff0000, v178
    v_sub_f32 v176, v176, v178
    v_cvt_pk_bf16_f32 v177, v177, v178
    v_cvt_pk_bf16_f32 v178, v176, 0
    v_cndmask_b32 v22, v177, v22, vcc
    v_cndmask_b32 v23, v178, v23, vcc
    v_mov_b32 v176, v169
    s_nop 1
    v_permlane32_swap_b32 v169, v176
    v_max_f32 v176, v169, v176
    v_sub_f32 v176, 0, v176
    v_cvt_pk_bf16_f32 v177, v176, v176
    v_and_b32 v177, 0xffff0000, v177
    v_sub_f32 v176, v176, v177
    v_cvt_pk_bf16_f32 v178, v176, v176
    v_and_b32 v178, 0xffff0000, v178
    v_sub_f32 v176, v176, v178
    v_cvt_pk_bf16_f32 v177, v177, v178
    v_cvt_pk_bf16_f32 v178, v176, 0
    v_cndmask_b32 v30, v177, v30, vcc
    v_cndmask_b32 v31, v178, v31, vcc
    v_mov_b32 v176, v170
    s_nop 1
    v_permlane32_swap_b32 v170, v176
    v_max_f32 v176, v170, v176
    v_sub_f32 v176, 0, v176
    v_cvt_pk_bf16_f32 v177, v176, v176
    v_and_b32 v177, 0xffff0000, v177
    v_sub_f32 v176, v176, v177
    v_cvt_pk_bf16_f32 v178, v176, v176
    v_and_b32 v178, 0xffff0000, v178
    v_sub_f32 v176, v176, v178
    v_cvt_pk_bf16_f32 v177, v177, v178
    v_cvt_pk_bf16_f32 v178, v176, 0
    v_cndmask_b32 v38, v177, v38, vcc
    v_cndmask_b32 v39, v178, v39, vcc
    v_mov_b32 v176, v171
    s_nop 1
    v_permlane32_swap_b32 v171, v176
    v_max_f32 v176, v171, v176
    v_sub_f32 v176, 0, v176
    v_cvt_pk_bf16_f32 v177, v176, v176
    v_and_b32 v177, 0xffff0000, v177
    v_sub_f32 v176, v176, v177
    v_cvt_pk_bf16_f32 v178, v176, v176
    v_and_b32 v178, 0xffff0000, v178
    v_sub_f32 v176, v176, v178
    v_cvt_pk_bf16_f32 v177, v177, v178
    v_cvt_pk_bf16_f32 v178, v176, 0
    v_cndmask_b32 v46, v177, v46, vcc
    v_cndmask_b32 v47, v178, v47, vcc
    s_nop 1
    s_branch L_fast
L_kvretryt:
    s_mov_b32 s15, 200000
L_kvpollt:
    buffer_load_dwordx3 v[188:190], v46, s[68:71], s72 offen sc1
    s_waitcnt vmcnt(0)
    v_cmp_eq_u32 s[16:17], s6, v190
    v_cmp_eq_u32 vcc, s6, v190
    s_and_b64 s[16:17], s[16:17], vcc
    s_cmp_eq_u64 s[16:17], -1
    s_cbranch_scc1 L_kvokt
    s_sleep 2
    s_sub_u32 s15, s15, 1
    s_cmp_lg_u32 s15, 0
    s_cbranch_scc1 L_kvpollt
    s_branch L_kvokt
L_kvretryl:
    s_mov_b32 s15, 200000
L_kvpolll:
    buffer_load_dwordx2 v[48:49], v29, s[68:71], s73 offen offset:0 sc1
    s_waitcnt vmcnt(0)
    v_cmp_eq_u32 s[16:17], s6, v48
    v_cmp_eq_u32 vcc, s6, v48
    s_and_b64 s[16:17], s[16:17], vcc
    s_cmp_eq_u64 s[16:17], -1
    s_cbranch_scc1 L_kvokl
    s_sleep 2
    s_sub_u32 s15, s15, 1
    s_cmp_lg_u32 s15, 0
    s_cbranch_scc1 L_kvpolll
    s_branch L_kvokl
L_csr:
    s_mov_b32 s15, 200000
L_csr_l:
    buffer_load_dwordx2 v[200:201], v15, s[68:71], s97 offen offset:0 sc1
    buffer_load_dwordx2 v[202:203], v15, s[68:71], s97 offen offset:512 sc1
    buffer_load_dwordx2 v[204:205], v15, s[68:71], s97 offen offset:1024 sc1
    buffer_load_dwordx2 v[206:207], v15, s[68:71], s97 offen offset:1536 sc1
    buffer_load_dwordx2 v[232:233], v15, s[68:71], s97 offen offset:2048 sc1
    buffer_load_dwordx2 v[234:235], v15, s[68:71], s97 offen offset:2560 sc1
    buffer_load_dwordx2 v[236:237], v15, s[68:71], s97 offen offset:3072 sc1
    buffer_load_dwordx2 v[238:239], v15, s[68:71], s97 offen offset:3584 sc1
    s_waitcnt vmcnt(0)
    v_min3_u32 v154, v201, v203, v248
    v_max3_u32 v155, v201, v203, v248
    v_min3_u32 v154, v205, v207, v154
    v_max3_u32 v155, v205, v207, v155
    v_min3_u32 v154, v233, v235, v154
    v_max3_u32 v155, v233, v235, v155
    v_min3_u32 v154, v237, v239, v154
    v_max3_u32 v155, v237, v239, v155
    v_cmp_ne_u32 vcc, v154, v155
    s_cbranch_vccz L_cs_ok
    s_sub_u32 s15, s15, 1
    s_cbranch_scc0 L_csr_l
    s_branch L_cs_ok
L_or28:
    buffer_load_dwordx4 v[112:115], v251, s[68:71], s96 offen offset:0 sc1
    buffer_load_dwordx4 v[116:119], v252, s[68:71], s96 offen offset:0 sc1
    buffer_load_dwordx4 v[128:131], v251, s[68:71], s96 offen offset:1024 sc1
    buffer_load_dwordx4 v[132:135], v252, s[68:71], s96 offen offset:1024 sc1
    buffer_load_dwordx4 v[144:147], v251, s[68:71], s97 offen offset:0 sc1
    buffer_load_dwordx4 v[148:151], v252, s[68:71], s97 offen offset:0 sc1
    buffer_load_dwordx4 v[120:123], v251, s[68:71], s97 offen offset:1024 sc1
    buffer_load_dwordx4 v[124:127], v252, s[68:71], s97 offen offset:1024 sc1
    buffer_load_dwordx4 v[176:179], v251, s[68:71], s98 offen offset:0 sc1
    buffer_load_dwordx4 v[180:183], v252, s[68:71], s98 offen offset:0 sc1
    buffer_load_dwordx4 v[168:171], v251, s[68:71], s98 offen offset:1024 sc1
    buffer_load_dwordx4 v[172:175], v252, s[68:71], s98 offen offset:1024 sc1
    s_waitcnt vmcnt(10)
    v_xor_b32 v115, s81, v115
    v_xor_b32 v119, s81, v119
    v_or_b32 v9, v115, v119
    v_cmp_ne_u16 vcc, 0, v9
    s_cbranch_vccz L_ok28
    s_sub_u32 s15, s15, 1
    s_cbranch_scc0 L_or28
    s_mov_b32 s15, 0
    s_branch L_ok28
L_or29:
    buffer_load_dwordx4 v[128:131], v251, s[68:71], s96 offen offset:1024 sc1
    buffer_load_dwordx4 v[132:135], v252, s[68:71], s96 offen offset:1024 sc1
    buffer_load_dwordx4 v[144:147], v251, s[68:71], s97 offen offset:0 sc1
    buffer_load_dwordx4 v[148:151], v252, s[68:71], s97 offen offset:0 sc1
    buffer_load_dwordx4 v[120:123], v251, s[68:71], s97 offen offset:1024 sc1
    buffer_load_dwordx4 v[124:127], v252, s[68:71], s97 offen offset:1024 sc1
    buffer_load_dwordx4 v[176:179], v251, s[68:71], s98 offen offset:0 sc1
    buffer_load_dwordx4 v[180:183], v252, s[68:71], s98 offen offset:0 sc1
    buffer_load_dwordx4 v[168:171], v251, s[68:71], s98 offen offset:1024 sc1
    buffer_load_dwordx4 v[172:175], v252, s[68:71], s98 offen offset:1024 sc1
    buffer_load_dwordx4 v[184:187], v251, s[68:71], s99 offen offset:0 sc1
    buffer_load_dwordx4 v[188:191], v252, s[68:71], s99 offen offset:0 sc1
    buffer_load_dwordx4 v[152:155], v251, s[68:71], s99 offen offset:1024 sc1
    buffer_load_dwordx4 v[156:159], v252, s[68:71], s99 offen offset:1024 sc1
    s_waitcnt vmcnt(12)
    v_xor_b32 v131, s81, v131
    v_xor_b32 v135, s81, v135
    v_or_b32 v9, v131, v135
    v_cmp_ne_u16 vcc, 0, v9
    s_cbranch_vccz L_ok29
    s_sub_u32 s15, s15, 1
    s_cbranch_scc0 L_or29
    s_mov_b32 s15, 0
    s_branch L_ok29
L_or30:
    buffer_load_dwordx4 v[144:147], v251, s[68:71], s97 offen offset:0 sc1
    buffer_load_dwordx4 v[148:151], v252, s[68:71], s97 offen offset:0 sc1
    buffer_load_dwordx4 v[120:123], v251, s[68:71], s97 offen offset:1024 sc1
    buffer_load_dwordx4 v[124:127], v252, s[68:71], s97 offen offset:1024 sc1
    buffer_load_dwordx4 v[176:179], v251, s[68:71], s98 offen offset:0 sc1
    buffer_load_dwordx4 v[180:183], v252, s[68:71], s98 offen offset:0 sc1
    buffer_load_dwordx4 v[168:171], v251, s[68:71], s98 offen offset:1024 sc1
    buffer_load_dwordx4 v[172:175], v252, s[68:71], s98 offen offset:1024 sc1
    buffer_load_dwordx4 v[184:187], v251, s[68:71], s99 offen offset:0 sc1
    buffer_load_dwordx4 v[188:191], v252, s[68:71], s99 offen offset:0 sc1
    buffer_load_dwordx4 v[152:155], v251, s[68:71], s99 offen offset:1024 sc1
    buffer_load_dwordx4 v[156:159], v252, s[68:71], s99 offen offset:1024 sc1
    s_waitcnt vmcnt(10)
    v_xor_b32 v147, s81, v147
    v_xor_b32 v151, s81, v151
    v_or_b32 v9, v147, v151
    v_cmp_ne_u16 vcc, 0, v9
    s_cbranch_vccz L_ok30
    s_sub_u32 s15, s15, 1
    s_cbranch_scc0 L_or30
    s_mov_b32 s15, 0
    s_branch L_ok30
L_or31:
    buffer_load_dwordx4 v[120:123], v251, s[68:71], s97 offen offset:1024 sc1
    buffer_load_dwordx4 v[124:127], v252, s[68:71], s97 offen offset:1024 sc1
    buffer_load_dwordx4 v[176:179], v251, s[68:71], s98 offen offset:0 sc1
    buffer_load_dwordx4 v[180:183], v252, s[68:71], s98 offen offset:0 sc1
    buffer_load_dwordx4 v[168:171], v251, s[68:71], s98 offen offset:1024 sc1
    buffer_load_dwordx4 v[172:175], v252, s[68:71], s98 offen offset:1024 sc1
    buffer_load_dwordx4 v[184:187], v251, s[68:71], s99 offen offset:0 sc1
    buffer_load_dwordx4 v[188:191], v252, s[68:71], s99 offen offset:0 sc1
    buffer_load_dwordx4 v[152:155], v251, s[68:71], s99 offen offset:1024 sc1
    buffer_load_dwordx4 v[156:159], v252, s[68:71], s99 offen offset:1024 sc1
    s_waitcnt vmcnt(8)
    v_xor_b32 v123, s81, v123
    v_xor_b32 v127, s81, v127
    v_or_b32 v9, v123, v127
    v_cmp_ne_u16 vcc, 0, v9
    s_cbranch_vccz L_ok31
    s_sub_u32 s15, s15, 1
    s_cbranch_scc0 L_or31
    s_mov_b32 s15, 0
    s_branch L_ok31
L_or32:
    buffer_load_dwordx4 v[176:179], v251, s[68:71], s98 offen offset:0 sc1
    buffer_load_dwordx4 v[180:183], v252, s[68:71], s98 offen offset:0 sc1
    buffer_load_dwordx4 v[168:171], v251, s[68:71], s98 offen offset:1024 sc1
    buffer_load_dwordx4 v[172:175], v252, s[68:71], s98 offen offset:1024 sc1
    buffer_load_dwordx4 v[184:187], v251, s[68:71], s99 offen offset:0 sc1
    buffer_load_dwordx4 v[188:191], v252, s[68:71], s99 offen offset:0 sc1
    buffer_load_dwordx4 v[152:155], v251, s[68:71], s99 offen offset:1024 sc1
    buffer_load_dwordx4 v[156:159], v252, s[68:71], s99 offen offset:1024 sc1
    s_waitcnt vmcnt(6)
    v_xor_b32 v179, s81, v179
    v_xor_b32 v183, s81, v183
    v_or_b32 v9, v179, v183
    v_cmp_ne_u16 vcc, 0, v9
    s_cbranch_vccz L_ok32
    s_sub_u32 s15, s15, 1
    s_cbranch_scc0 L_or32
    s_mov_b32 s15, 0
    s_branch L_ok32
L_or33:
    buffer_load_dwordx4 v[168:171], v251, s[68:71], s98 offen offset:1024 sc1
    buffer_load_dwordx4 v[172:175], v252, s[68:71], s98 offen offset:1024 sc1
    buffer_load_dwordx4 v[184:187], v251, s[68:71], s99 offen offset:0 sc1
    buffer_load_dwordx4 v[188:191], v252, s[68:71], s99 offen offset:0 sc1
    buffer_load_dwordx4 v[152:155], v251, s[68:71], s99 offen offset:1024 sc1
    buffer_load_dwordx4 v[156:159], v252, s[68:71], s99 offen offset:1024 sc1
    s_waitcnt vmcnt(4)
    v_xor_b32 v171, s81, v171
    v_xor_b32 v175, s81, v175
    v_or_b32 v9, v171, v175
    v_cmp_ne_u16 vcc, 0, v9
    s_cbranch_vccz L_ok33
    s_sub_u32 s15, s15, 1
    s_cbranch_scc0 L_or33
    s_mov_b32 s15, 0
    s_branch L_ok33
L_or34:
    buffer_load_dwordx4 v[184:187], v251, s[68:71], s99 offen offset:0 sc1
    buffer_load_dwordx4 v[188:191], v252, s[68:71], s99 offen offset:0 sc1
    buffer_load_dwordx4 v[152:155], v251, s[68:71], s99 offen offset:1024 sc1
    buffer_load_dwordx4 v[156:159], v252, s[68:71], s99 offen offset:1024 sc1
    s_waitcnt vmcnt(2)
    v_xor_b32 v187, s81, v187
    v_xor_b32 v191, s81, v191
    v_or_b32 v9, v187, v191
    v_cmp_ne_u16 vcc, 0, v9
    s_cbranch_vccz L_ok34
    s_sub_u32 s15, s15, 1
    s_cbranch_scc0 L_or34
    s_mov_b32 s15, 0
    s_branch L_ok34
L_or35:
    buffer_load_dwordx4 v[152:155], v251, s[68:71], s99 offen offset:1024 sc1
    buffer_load_dwordx4 v[156:159], v252, s[68:71], s99 offen offset:1024 sc1
    s_waitcnt vmcnt(0)
    v_xor_b32 v155, s81, v155
    v_xor_b32 v159, s81, v159
    v_or_b32 v9, v155, v159
    v_cmp_ne_u16 vcc, 0, v9
    s_cbranch_vccz L_ok35
    s_sub_u32 s15, s15, 1
    s_cbranch_scc0 L_or35
    s_mov_b32 s15, 0
    s_branch L_ok35
L_kvretrys:
    s_mov_b32 s15, 200000
L_kvpolls:
    buffer_load_dwordx3 v[128:130], v10, s[68:71], s82 offen sc1
    buffer_load_dwordx2 v[248:249], v11, s[68:71], s81 offen sc1
    buffer_load_dwordx2 v[250:251], v11, s[68:71], s81 offen offset:128 sc1
    s_waitcnt vmcnt(0)
    v_cmp_eq_u32 s[16:17], s6, v130
    v_cmp_eq_u32 s[18:19], s6, v248
    v_cmp_eq_u32 vcc, s6, v250
    s_and_b64 s[16:17], s[16:17], s[18:19]
    s_and_b64 s[16:17], s[16:17], vcc
    s_cmp_eq_u64 s[16:17], -1
    s_cbranch_scc1 L_kvoks
    s_sleep 2
    s_sub_u32 s15, s15, 1
    s_cmp_lg_u32 s15, 0
    s_cbranch_scc1 L_kvpolls
    s_branch L_kvoks
L_f1:
    s_mov_b32 s15, 200000
L_f1_l:
    ds_read_b32 v176, v173 offset:16
    s_waitcnt lgkmcnt(0)
    v_cmp_gt_u32 vcc, s90, v176
    s_cbranch_vccz L_f1_ok
    s_sub_u32 s15, s15, 1
    s_cbranch_scc0 L_f1_l
    s_branch L_f1_ok
L_f2:
    s_mov_b32 s15, 200000
L_f2_l:
    ds_read_b32 v176, v173 offset:0
    s_waitcnt lgkmcnt(0)
    v_cmp_gt_u32 vcc, 2, v176
    s_cbranch_vccz L_f2_ok
    s_sub_u32 s15, s15, 1
    s_cbranch_scc0 L_f2_l
    s_branch L_f2_ok
L_f3:
    s_mov_b32 s15, 200000
L_f3_l:
    ds_read_b32 v176, v173 offset:0
    s_waitcnt lgkmcnt(0)
    v_cmp_gt_u32 vcc, 3, v176
    s_cbranch_vccz L_f3_ok
    s_sub_u32 s15, s15, 1
    s_cbranch_scc0 L_f3_l
    s_branch L_f3_ok
L_code_end:
    s_endpgm
.section .rodata,"a"
.p2align 6
.amdhsa_kernel parallel_sum__grouped_kv_mqa__glu_gated_bilinear__prompt_kernel
  .amdhsa_next_free_vgpr 256
  .amdhsa_next_free_sgpr 102
  .amdhsa_accum_offset 256
  .amdhsa_group_segment_fixed_size 0
  .amdhsa_kernarg_size 96
  .amdhsa_user_sgpr_count 2
  .amdhsa_user_sgpr_kernarg_segment_ptr 1
  .amdhsa_system_sgpr_workgroup_id_x 1
.end_amdhsa_kernel
```
